```python
import torch

def _softmax(x, axis=-1):
    return torch.softmax(x, dim=axis)

def _gelu(x):
    return torch.nn.functional.gelu(x, approximate='tanh')

def _silu(x):
    return torch.nn.functional.silu(x)

def _sigmoid(x):
    return torch.sigmoid(x)

def _layernorm(x, axis=-1, eps=1e-05):
    m = x.mean(dim=axis, keepdim=True)
    v = x.var(dim=axis, keepdim=True, unbiased=False)
    return (x - m) / torch.sqrt(v + eps)

def _scatter_add(tgt, idx, src, axis=0):
    return tgt.clone().index_add_(axis, idx, src)

def _segment_sum(src, seg, n):
    out = torch.zeros((n,) + src.shape[1:], dtype=src.dtype)
    return out.index_add_(0, seg, src)

def _pad(x, pw):
    flat = tuple((v for pair in reversed(pw) for v in pair))
    return torch.nn.functional.pad(x, flat)
kernel_name = 'adaLN_cond__sliding_block__mixer_channel_mlp__prompt'

def setup_inputs():

    _w = lambda a: (lambda t: t.to(torch.bfloat16) if t.is_floating_point() else t)(torch.as_tensor(a))

    def _A_setup():
        B, S, D = (1, 2048, 512)
        return {'x': _w((lambda *s: torch.randn(*s, dtype=torch.bfloat16) * 0.05)(B, S, D)), 'wqkv': _w((lambda *s: torch.randn(*s, dtype=torch.bfloat16) * 0.05)(D, 3 * D)), 'wo': _w((lambda *s: torch.randn(*s, dtype=torch.bfloat16) * 0.05)(D, D))}
    _A_in = _A_setup()

    def _B_setup():
        B, S, D, F = (1, 2048, 512, 1792)
        return {'x': _w((lambda *s: torch.randn(*s, dtype=torch.bfloat16) * 0.05)(B, S, D)), 'w1': _w((lambda *s: torch.randn(*s, dtype=torch.bfloat16) * 3.2)(D, F) * D ** (-0.5)), 'b1': _w((lambda *s: torch.randn(*s, dtype=torch.bfloat16) * 1.6)(F)), 'w2': _w((lambda *s: torch.randn(*s, dtype=torch.bfloat16) * 0.2)(F, D) * F ** (-0.5)), 'b2': _w((lambda *s: torch.randn(*s, dtype=torch.bfloat16) * 0.4)(D))}
    _B_in = _B_setup()
    return {'A_x': _A_in['x'], 'A_wqkv': _A_in['wqkv'], 'A_wo': _A_in['wo'], 'B_x': _B_in['x'], 'B_w1': _B_in['w1'], 'B_b1': _B_in['b1'], 'B_w2': _B_in['w2'], 'B_b2': _B_in['b2'], 'c': _w((lambda *s: torch.randn(*s, dtype=torch.bfloat16) * 0.1)(1, 512) * 8.0), 'w_mod': _w((lambda *s: torch.randn(*s, dtype=torch.bfloat16) * 0.1)(512, 6 * 512) * 512 ** (-0.5) * 8.0)}

def reference(A_x, A_wqkv, A_wo, B_x, B_w1, B_b1, B_w2, B_b2, c, w_mod):

    def _A_ref(x, wqkv, wo):
        B, S, D = x.shape
        H = 32
        Dh = D // H
        W = 256
        qkv = (lambda x, *d: x.permute(*d))((x @ wqkv).reshape(B, S, 3, H, Dh), 2, 0, 3, 1, 4)
        q, k, v = (qkv[0], qkv[1], qkv[2])
        scores = torch.einsum('bhqd,bhkd->bhqk', q, k) * Dh ** (-0.5)
        idx = torch.arange(S)
        mask = (idx[:, None] - idx[None, :] >= 0) & (idx[:, None] - idx[None, :] < W)
        scores = torch.where(mask[None, None], scores, -1000000000.0)
        p = _softmax(scores, axis=-1)
        o = torch.einsum('bhqk,bhkd->bhqd', p, v)
        return (lambda x, *d: x.permute(*d))(o, 0, 2, 1, 3).reshape(B, S, D) @ wo

    def _B_ref(x, w1, b1, w2, b2):
        y = _layernorm(x, axis=-1)
        h = _gelu(torch.einsum('bsd,df->bsf', y, w1) + b1)
        return torch.einsum('bsf,fd->bsd', h, w2) + b2
    x = A_x
    mod = (_silu(c) @ w_mod).reshape(c.shape[0], 6, 1, -1)
    sa, ca, ga, sb, cb, gb = (mod[:, 0].clone(), mod[:, 1].clone(), mod[:, 2].clone(), mod[:, 3].clone(), mod[:, 4].clone(), mod[:, 5].clone())
    h = _layernorm(x, axis=-1) * (1 + ca) + sa
    x = x + ga * _A_ref(h, A_wqkv, A_wo)
    h = _layernorm(x, axis=-1) * (1 + cb) + sb
    x = x + gb * _B_ref(h, B_w1, B_b1, B_w2, B_b2)
    return x
```

```asm
; @launch grid=(256,1,1) block=(256,1,1) lds=163840
.amdgcn_target "amdgcn-amd-amdhsa--gfx950"
.text
.globl adaLN_cond__sliding_block__mixer_channel_mlp__prompt_kernel
.p2align 8
.type adaLN_cond__sliding_block__mixer_channel_mlp__prompt_kernel,@function
adaLN_cond__sliding_block__mixer_channel_mlp__prompt_kernel:
  s_cmp_ge_u32 s2, 256
  s_cbranch_scc1 Lexit
  s_load_dwordx16 s[16:31], s[0:1], 0
  s_load_dwordx8 s[32:39], s[0:1], 64
  s_load_dwordx2 s[40:41], s[0:1], 96
  v_lshrrev_b32 v8, 6, v0
  v_and_b32 v1, 63, v0
  v_readfirstlane_b32 s92, v8
  v_lshlrev_b32 v2, 4, v1
  s_and_b32 s6, s2, 7
  s_lshr_b32 s7, s2, 3
  s_lshr_b32 s98, s2, 7
  s_lshl_b32 s93, s6, 1
  s_add_u32 s93, s93, s98
  s_and_b32 s94, s7, 15
  s_lshr_b32 s8, s2, 2
  s_and_b32 s9, s2, 3
  v_lshrrev_b32 v8, 3, v0
  v_mul_u32_u24 v12, 24576, v8
  v_and_b32 v9, 7, v0
  v_lshl_add_u32 v12, v9, 4, v12
  v_lshlrev_b32 v13, 3, v8
  v_and_b32 v8, 32, v1
  v_lshl_add_u32 v14, v8, 4, v2
  s_mul_i32 s98, s9, 0xc0000
  s_lshl_b32 s4, s8, 7
  s_add_u32 s98, s98, s4
  s_lshl_b32 s99, s9, 8
  s_lshl_b32 s3, s93, 17
  s_lshl_b32 s4, s94, 13
  s_add_u32 s3, s3, s4
  s_lshl_b32 s4, s92, 11
  s_add_u32 s3, s3, s4
  s_mov_b32 s78, 3145728
  s_mov_b32 s79, 0x20000
  s_mov_b32 s74, 1024
  s_mov_b32 s75, 0x20000
  s_mov_b32 s46, 2097152
  s_mov_b32 s47, 0x20000
  s_waitcnt lgkmcnt(0)
  s_mov_b32 s76, s34
  s_and_b32 s77, s35, 0xffff
  s_mov_b32 s72, s32
  s_and_b32 s73, s33, 0xffff
  s_mov_b32 s44, s16
  s_and_b32 s45, s17, 0xffff
  s_cmp_lt_u32 s2, 192
  s_cselect_b64 exec, -1, 0
  buffer_load_dwordx2 v[32:33], v13, s[72:75], s99 offen
  buffer_load_dwordx4 v[16:19], v12, s[76:79], s98 offen
  s_add_u32 s98, s98, 6144
  buffer_load_dwordx4 v[20:23], v12, s[76:79], s98 offen
  s_add_u32 s98, s98, 6144
  buffer_load_dwordx4 v[24:27], v12, s[76:79], s98 offen
  s_add_u32 s98, s98, 6144
  buffer_load_dwordx4 v[28:31], v12, s[76:79], s98 offen
  s_mov_b64 exec, -1
  buffer_load_dwordx4 v[36:39], v14, s[44:47], s3 offen
  buffer_load_dwordx4 v[40:43], v14, s[44:47], s3 offen offset:512
  s_load_dword s95, s[40:41], 0
  s_getpc_b64 s[88:89]
Lpf_pc:
  v_lshlrev_b32 v8, 7, v0
  v_min_u32 v8, Lcode_end-Lpf_pc-64, v8
  s_cmp_ge_u32 s2, 248
  s_cselect_b64 exec, -1, 0
  global_load_dword v5, v8, s[88:89]
  v_lshlrev_b32 v8, 5, v0
  v_add_u32 v8, 32768, v8
  v_min_u32 v8, Lcode_end-Lpf_pc-64, v8
  global_load_dword v5, v8, s[88:89]
  s_mov_b64 exec, -1
  v_lshlrev_b32 v6, 7, v1
  s_mov_b32 s48, s18
  s_and_b32 s49, s19, 0xffff
  s_mov_b32 s50, 1572864
  s_mov_b32 s51, 0x20000
  s_mul_i32 s98, s2, 0x1800
  s_mul_i32 s4, s92, 0x600
  s_add_u32 s98, s98, s4
  s_mov_b64 exec, 0xfff
  buffer_load_dword v5, v6, s[48:51], s98 offen
  s_mov_b64 exec, -1
  v_mov_b32 v4, 0
  s_getreg_b32 s5, hwreg(HW_REG_XCC_ID)
  s_mov_b32 s84, s40
  s_and_b32 s85, s41, 0xffff
  s_mov_b32 s86, 33554432
  s_mov_b32 s87, 0x20000
  s_mov_b32 s64, s28
  s_and_b32 s65, s29, 0xffff
  s_mov_b32 s66, 1835008
  s_mov_b32 s67, 0x20000
  s_mov_b32 s56, s24
  s_and_b32 s57, s25, 0xffff
  s_mov_b32 s58, 1835008
  s_mov_b32 s59, 0x20000
  s_mov_b32 s52, s20
  s_and_b32 s53, s21, 0xffff
  s_mov_b32 s54, 524288
  s_mov_b32 s55, 0x20000
  s_mov_b32 s60, s26
  s_and_b32 s61, s27, 0xffff
  s_mov_b32 s62, 3584
  s_mov_b32 s63, 0x20000
  s_mov_b32 s68, s30
  s_and_b32 s69, s31, 0xffff
  s_mov_b32 s70, 1024
  s_mov_b32 s71, 0x20000
  s_mov_b32 s80, s36
  s_and_b32 s81, s37, 0xffff
  s_mov_b32 s82, 2097152
  s_mov_b32 s83, 0x20000
  s_lshl_b32 s90, s93, 17
  s_lshl_b32 s4, s92, 15
  s_add_u32 s90, s90, s4
  s_mov_b32 s91, s90
  s_lshl_b32 s4, s94, 11
  s_add_u32 s91, s91, s4
  s_add_u32 s91, s91, 0x100000
  s_lshl_b32 s74, s93, 8
  s_lshl_b32 s4, s92, 6
  s_add_u32 s74, s74, s4
  s_lshl_b32 s4, s94, 2
  s_add_u32 s74, s74, s4
  v_add_u32 v15, s91, v6
  s_add_u32 s98, s74, 4096
  v_writelane_b32 v15, s98, 16
  s_and_b32 s72, s94, 1
  s_and_b32 s98, s94, 6
  s_cmp_eq_u32 s98, 6
  s_cselect_b32 s75, 8, 0
  s_xor_b32 s76, s94, s75
  s_lshr_b32 s98, s76, 1
  s_lshl_b32 s77, s92, 14
  s_mul_i32 s78, s92, 0x60000
  s_lshl_b32 s4, s72, 10
  s_add_u32 s78, s78, s4
  s_lshl_b32 s4, s98, 7
  s_add_u32 s78, s78, s4
  s_add_u32 s78, s78, 0x400
  v_lshrrev_b32 v10, 3, v1
  v_and_b32 v11, 7, v1
  v_lshlrev_b32 v11, 4, v11
  v_lshl_add_u32 v13, v10, 10, v11
  v_and_b32 v9, 16, v1
  v_lshlrev_b32 v9, 2, v9
  v_xor_b32 v11, v11, v9
  v_mul_u32_u24 v12, 3072, v10
  v_add_u32 v12, v12, v11
  v_lshrrev_b32 v8, 5, v1
  v_and_b32 v9, 31, v1
  v_lshlrev_b32 v52, 10, v9
  v_lshl_add_u32 v53, v8, 5, v52
  v_lshrrev_b32 v10, 2, v1
  v_and_b32 v11, 3, v1
  v_lshlrev_b32 v11, 4, v11
  v_lshl_add_u32 v52, v10, 10, v11
  s_mov_b32 s98, s90
  s_lshl_b32 s4, s94, 6
  s_add_u32 s98, s98, s4
  s_lshl_b32 s99, s92, 11
  s_add_u32 s99, s99, 0x1a000
  s_mov_b32 m0, s99
  s_add_u32 s99, s98, 15360
  buffer_load_dwordx4 v52, s[44:47], s98 offen lds
  buffer_load_dwordx4 v52, s[44:47], s99 offen offset:1024 lds
  v_and_b32 v9, 1, v1
  v_lshlrev_b32 v54, 5, v9
  v_and_b32 v9, 16, v1
  v_add_u32 v54, v54, v9
  v_bfe_u32 v9, v1, 1, 1
  v_lshl_add_u32 v54, v9, 3, v54
  v_lshrrev_b32_e64 v8, 5, v1
  v_bfe_u32 v9, v1, 2, 2
  v_lshl_add_u32 v57, v8, 3, v9
  v_lshl_add_u32 v55, v57, 7, v54
  v_and_b32 v8, 7, v1
  v_lshlrev_b32 v8, 5, v8
  v_lshrrev_b32 v9, 4, v1
  v_lshl_add_u32 v8, v9, 3, v8
  s_lshl_b32 s98, s92, 8
  s_add_u32 s98, s98, 0x27000
  v_add_u32 v56, s98, v8
  v_and_b32 v8, 15, v1
  v_lshlrev_b32 v76, 2, v8
  s_and_b32 s98, s74, 0xffffffc0
  v_add_u32 v76, s98, v76
  v_lshlrev_b32 v8, 3, v8
  s_lshl_b32 s98, s92, 5
  v_add_u32 v9, s98, v1
  v_cmp_gt_u32 vcc, 32, v1
  s_nop 1
  v_cndmask_b32 v70, v8, v9, vcc
  s_lshl_b32 s98, s93, 11
  s_add_u32 s98, s98, 0x18000
  v_lshl_add_u32 v70, v70, 4, s98
  v_lshrrev_b32 v8, 5, v1
  v_and_b32 v9, 31, v1
  v_lshl_add_u32 v71, v8, 9, v9
  s_lshl_b32 s98, s94, 8
  s_add_u32 s98, s98, 0x40000
  v_lshl_add_u32 v71, v71, 3, s98
  v_cvt_f32_u32 v72, v8
  v_lshlrev_b32 v73, 2, v0
  v_add_u32 v73, 155648, v73
  s_lshl_b32 s98, s92, 8
  s_add_u32 s98, s98, 0x26400
  v_lshl_add_u32 v74, v8, 5, s98
  v_lshl_add_u32 v75, v1, 2, s98
  v_lshlrev_b32 v77, 2, v1
  v_add_u32 v77, 159744, v77
  v_lshlrev_b32 v78, 3, v1
  v_add_u32 v79, 160768, v78
  v_lshrrev_b32 v80, 2, v1
  s_lshl_b32 s98, s92, 4
  s_add_u32 s98, s98, 0x27400
  v_add_u32 v80, s98, v80
  s_lshl_b32 s79, s93, 11
  s_lshl_b32 s4, s94, 7
  s_add_u32 s79, s79, s4
  s_add_u32 s79, s79, 0x18000
  s_lshl_b32 s10, s9, 13
  s_lshl_b32 s4, s8, 9
  s_add_u32 s10, s10, s4
  s_add_u32 s10, s10, 0x40000
  s_lshl_b32 s11, s8, 10
  s_lshl_b32 s4, s9, 2
  s_add_u32 s11, s11, s4
  s_add_u32 s11, s11, 0x44000
  s_lshl_b32 s98, s93, 13
  s_lshl_b32 s4, s94, 9
  s_add_u32 s98, s98, s4
  s_lshl_b32 s4, s92, 7
  s_add_u32 s98, s98, s4
  s_add_u32 s98, s98, 0x20000
  v_add_u32 v8, s10, v6
  v_writelane_b32 v8, s79, 4
  v_writelane_b32 v8, s98, 5
  s_cmp_lt_u32 s2, 64
  s_cselect_b32 exec_lo, 63, 48
  s_mov_b32 exec_hi, 0
  buffer_load_dword v5, v8, s[84:87], 0 offen
  s_mov_b64 exec, -1
  s_mov_b64 exec, 131071
  buffer_load_dword v5, v15, s[84:87], 0 offen
  s_mov_b64 exec, -1
  s_lshl_b32 s98, s7, 14
  s_lshl_b32 s4, s6, 7
  s_add_u32 s98, s98, s4
  s_add_u32 s99, s98, 7168
  s_mov_b32 m0, 98304
  s_cmp_eq_u32 s92, 2
  s_cselect_b64 exec, -1, 0
  buffer_load_dwordx4 v13, s[52:55], s98 offen lds
  buffer_load_dwordx4 v13, s[52:55], s99 offen offset:1024 lds
  s_mov_b64 exec, -1
  s_mov_b32 s98, 0xbfb8aa3b
  s_waitcnt vmcnt(15)
  v_and_b32 v35, 0xffff0000, v33
  v_lshlrev_b32 v34, 16, v33
  v_and_b32 v33, 0xffff0000, v32
  v_lshlrev_b32 v32, 16, v32
  v_mul_f32 v90, s98, v32
  v_mul_f32 v91, s98, v33
  v_mul_f32 v92, s98, v34
  v_mul_f32 v93, s98, v35
  v_exp_f32 v90, v90
  v_exp_f32 v91, v91
  v_exp_f32 v92, v92
  v_exp_f32 v93, v93
  v_add_f32 v90, 1.0, v90
  v_add_f32 v91, 1.0, v91
  v_add_f32 v92, 1.0, v92
  v_add_f32 v93, 1.0, v93
  v_rcp_f32 v90, v90
  v_rcp_f32 v91, v91
  v_rcp_f32 v92, v92
  v_rcp_f32 v93, v93
  v_mul_f32 v32, v32, v90
  v_mul_f32 v33, v33, v91
  v_mul_f32 v34, v34, v92
  v_mul_f32_e64 v35, v35, v93
  v_cvt_pk_bf16_f32 v90, v32, 0
  v_cvt_pk_bf16_f32 v94, 0, v32
  v_cvt_pk_bf16_f32 v91, v33, 0
  v_cvt_pk_bf16_f32 v95, 0, v33
  v_cvt_pk_bf16_f32 v92, v34, 0
  v_cvt_pk_bf16_f32 v96, 0, v34
  v_cvt_pk_bf16_f32 v93, v35, 0
  v_cvt_pk_bf16_f32 v97, 0, v35
  s_waitcnt vmcnt(14)
  s_nop 0
  v_dot2_f32_bf16 v82, v16, v90, 0
  v_dot2_f32_bf16 v83, v16, v94, 0
  v_dot2_f32_bf16 v84, v17, v90, 0
  v_dot2_f32_bf16 v85, v17, v94, 0
  v_dot2_f32_bf16 v86, v18, v90, 0
  v_dot2_f32_bf16 v87, v18, v94, 0
  v_dot2_f32_bf16 v88, v19, v90, 0
  v_dot2_f32_bf16 v89, v19, v94, 0
  s_waitcnt vmcnt(13)
  s_nop 0
  v_dot2_f32_bf16 v82, v20, v91, v82
  v_dot2_f32_bf16 v83, v20, v95, v83
  v_dot2_f32_bf16 v84, v21, v91, v84
  v_dot2_f32_bf16 v85, v21, v95, v85
  v_dot2_f32_bf16 v86, v22, v91, v86
  v_dot2_f32_bf16 v87, v22, v95, v87
  v_dot2_f32_bf16 v88, v23, v91, v88
  v_dot2_f32_bf16 v89, v23, v95, v89
  s_waitcnt vmcnt(12)
  s_nop 0
  v_dot2_f32_bf16 v82, v24, v92, v82
  v_dot2_f32_bf16 v83, v24, v96, v83
  v_dot2_f32_bf16 v84, v25, v92, v84
  v_dot2_f32_bf16 v85, v25, v96, v85
  v_dot2_f32_bf16 v86, v26, v92, v86
  v_dot2_f32_bf16 v87, v26, v96, v87
  v_dot2_f32_bf16 v88, v27, v92, v88
  v_dot2_f32_bf16 v89, v27, v96, v89
  s_waitcnt vmcnt(11)
  s_nop 0
  v_dot2_f32_bf16 v82, v28, v93, v82
  v_dot2_f32_bf16 v83, v28, v97, v83
  v_dot2_f32_bf16 v84, v29, v93, v84
  v_dot2_f32_bf16 v85, v29, v97, v85
  v_dot2_f32_bf16 v86, v30, v93, v86
  v_dot2_f32_bf16 v87, v30, v97, v87
  v_dot2_f32_bf16 v88, v31, v93, v88
  v_dot2_f32_bf16 v89, v31, v97, v89
  v_mov_b32 v10, 0x3f803f80
  v_permlane32_swap_b32 v82, v86
  v_permlane32_swap_b32 v83, v87
  v_permlane32_swap_b32 v84, v88
  v_permlane32_swap_b32 v85, v89
  v_add_f32 v82, v82, v86
  v_add_f32 v83, v83, v87
  v_add_f32 v84, v84, v88
  v_add_f32_e64 v85, v85, v89
  s_waitcnt vmcnt(10)
  v_dot2_f32_bf16 v8, v36, v10, 0
  v_dot2_f32_bf16 v9, v36, v36, 0
  v_dot2_f32_bf16 v8, v37, v10, v8
  v_dot2_f32_bf16 v9, v37, v37, v9
  v_dot2_f32_bf16 v8, v38, v10, v8
  v_dot2_f32_bf16 v9, v38, v38, v9
  v_dot2_f32_bf16 v8, v39, v10, v8
  v_dot2_f32_bf16 v9, v39, v39, v9
  s_waitcnt vmcnt(9)
  s_nop 0
  v_dot2_f32_bf16 v8, v40, v10, v8
  v_dot2_f32_bf16 v9, v40, v40, v9
  v_dot2_f32_bf16 v8, v41, v10, v8
  v_dot2_f32_bf16 v9, v41, v41, v9
  v_dot2_f32_bf16 v8, v42, v10, v8
  v_dot2_f32_bf16 v9, v42, v42, v9
  v_dot2_f32_bf16 v8, v43, v10, v8
  v_dot2_f32_bf16 v9, v43, v43, v9
  v_permlane16_swap_b32 v82, v84
  v_permlane16_swap_b32 v83, v85
  v_add_f32 v82, v82, v84
  v_add_f32 v83, v83, v85
  v_add_f32 v8, v8, v8 row_ror:8 row_mask:0xf bank_mask:0xf
  v_add_f32 v9, v9, v9 row_ror:8 row_mask:0xf bank_mask:0xf
  v_add_f32 v82, v82, v82 row_ror:8 row_mask:0xf bank_mask:0xf
  v_add_f32 v83, v83, v83 row_ror:8 row_mask:0xf bank_mask:0xf
  s_mov_b32 exec_lo, 0x00ff00ff
  s_mov_b32 exec_hi, 0x00ff00ff
  ds_write_b64 v56, v[82:83]
  s_mov_b64 exec, -1
  v_add_f32 v8, v8, v8 row_ror:4 row_mask:0xf bank_mask:0xf
  v_add_f32 v9, v9, v9 row_ror:4 row_mask:0xf bank_mask:0xf
  s_nop 0
  v_add_f32 v8, v8, v8 row_ror:2 row_mask:0xf bank_mask:0xf
  v_add_f32 v9, v9, v9 row_ror:2 row_mask:0xf bank_mask:0xf
  s_nop 0
  v_add_f32 v8, v8, v8 row_ror:1 row_mask:0xf bank_mask:0xf
  v_add_f32 v9, v9, v9 row_ror:1 row_mask:0xf bank_mask:0xf
  v_mov_b32 v36, v8
  v_mov_b32 v37, v9
  s_nop 0
  v_permlane16_swap_b32 v8, v36
  v_permlane16_swap_b32 v9, v37
  v_add_f32 v36, v8, v36
  v_add_f32 v37, v9, v37
  s_mov_b32 exec_lo, 1
  s_mov_b32 exec_hi, 1
  ds_write_b64 v80, v[36:37]
  s_mov_b64 exec, -1
  s_waitcnt lgkmcnt(0)
  s_mul_i32 s95, s95, 0x2c9277b5
  s_add_u32 s95, s95, 0xac564b05
  v_mov_b32 v3, s95
  s_barrier
  s_cmp_eq_u32 s92, 1
  s_cbranch_scc1 L_2
  s_cmp_eq_u32 s92, 0
  s_cbranch_scc1 L_1
L_4:
  v_and_b32 v10, 16, v1
  v_lshlrev_b32 v10, 1, v10
  v_and_b32_e64 v11, 3, v1
  v_lshl_add_u32 v10, v11, 3, v10
  v_lshl_add_u32 v17, v57, 6, v10
  v_add_u32 v17, 65536, v17
  v_lshl_add_u32 v56, v57, 7, v10
  v_bfe_u32 v11, v1, 3, 1
  s_add_u32 m0, s77, 0
  s_add_u32 s73, s78, 0
  buffer_load_dwordx4 v12, s[48:51], s73 offen lds
  v_xor_b32 v11, s72, v11
  v_lshl_add_u32 v56, v11, 6, v56
  v_xor_b32 v16, 64, v56
  v_lshrrev_b32 v10, 2, v1
  v_and_b32 v11, 3, v1
  v_lshlrev_b32 v11, 4, v11
  v_mul_u32_u24 v20, 3072, v10
  v_add_u32 v20, v20, v11
  s_add_u32 m0, s77, 1024
  s_add_u32 s73, s78, 24576
  buffer_load_dwordx4 v12, s[48:51], s73 offen lds
  s_and_b32 s79, s94, 7
  s_lshr_b32 s8, s94, 3
  s_and_b32 s9, s92, 1
  s_lshr_b32 s10, s92, 1
  s_lshl_b32 s11, s92, 13
  s_mul_i32 s12, s92, 0x60000
  s_lshl_b32 s4, s76, 6
  s_add_u32 s12, s12, s4
  s_add_u32 m0, s77, 2048
  s_add_u32 s73, s78, 49152
  buffer_load_dwordx4 v12, s[48:51], s73 offen lds
  s_lshl_b32 s13, s2, 2
  s_mov_b32 s14, s90
  s_add_u32 s14, s14, 0x100000
  s_lshl_b32 s15, s93, 6
  s_lshl_b32 s4, s94, 2
  s_add_u32 s15, s15, s4
  s_add_u32 s15, s15, s92
  s_add_u32 m0, s77, 3072
  s_add_u32 s73, s78, 73728
  buffer_load_dwordx4 v12, s[48:51], s73 offen lds
  s_lshl_b32 s16, s15, 12
  s_lshl_b32 s4, s72, 11
  s_add_u32 s16, s16, s4
  s_add_u32 s16, s16, 0x700000
  s_xor_b32 s17, s16, 16384
  s_xor_b32 s18, s16, 2048
  s_min_u32 s98, s93, 1
  s_lshl_b32 s98, s98, 6
  s_sub_u32 s98, s15, s98
  s_add_u32 m0, s77, 4096
  s_add_u32 s73, s78, 98304
  buffer_load_dwordx4 v12, s[48:51], s73 offen lds
  s_min_u32 s99, s93, 2
  s_lshl_b32 s99, s99, 6
  s_sub_u32 s99, s15, s99
  s_lshl_b32 s19, s98, 12
  s_add_u32 s19, s19, 0x700000
  s_lshl_b32 s20, s99, 12
  s_add_u32 s20, s20, 0x700000
  s_add_u32 m0, s77, 5120
  s_add_u32 s73, s78, 122880
  buffer_load_dwordx4 v12, s[48:51], s73 offen lds
  s_xor_b32 s3, s15, 4
  v_mov_b32 v21, s3
  v_writelane_b32 v21, s99, 0
  v_writelane_b32 v21, s98, 2
  s_xor_b32 s99, s99, 4
  s_xor_b32 s98, s98, 4
  v_writelane_b32 v21, s99, 1
  v_writelane_b32 v21, s98, 3
  v_lshlrev_b32 v21, 7, v21
  s_lshl_b32 s15, s15, 7
  s_add_u32 m0, s77, 6144
  s_add_u32 s73, s78, 147456
  buffer_load_dwordx4 v12, s[48:51], s73 offen lds
  s_lshl_b32 s98, s92, 12
  s_add_u32 s98, s98, 0x1a000
  v_add_u32 v18, s98, v2
  s_lshl_b32 s98, s72, 11
  v_add_u32 v19, s98, v18
  v_and_b32 v9, 7, v1
  v_lshrrev_b32 v8, 3, v1
  v_mul_u32_u24 v8, 3072, v8
  v_lshl_add_u32 v22, v9, 7, v8
  s_add_u32 m0, s77, 7168
  s_add_u32 s73, s78, 172032
  buffer_load_dwordx4 v12, s[48:51], s73 offen lds
  s_mul_i32 s98, s7, 0xc000
  s_mul_i32 s4, s92, 0x3000
  s_add_u32 s98, s98, s4
  v_add_u32 v22, s98, v22
  s_lshl_b32 s21, s93, 2
  s_lshl_b32 s4, s8, 1
  s_add_u32 s21, s21, s4
  s_add_u32 s21, s21, s10
  s_add_u32 m0, s77, 8192
  s_add_u32 s73, s78, 196608
  buffer_load_dwordx4 v12, s[48:51], s73 offen lds
  s_lshl_b32 s22, s21, 15
  s_lshl_b32 s4, s79, 7
  s_add_u32 s22, s22, s4
  s_lshl_b32 s4, s9, 6
  s_add_u32 s22, s22, s4
  s_add_u32 m0, s77, 9216
  s_add_u32 s73, s78, 221184
  buffer_load_dwordx4 v12, s[48:51], s73 offen lds
  s_add_u32 m0, s77, 10240
  s_add_u32 s73, s78, 245760
  buffer_load_dwordx4 v12, s[48:51], s73 offen lds
  s_add_u32 m0, s77, 11264
  s_add_u32 s73, s78, 270336
  buffer_load_dwordx4 v12, s[48:51], s73 offen lds
  s_add_u32 m0, s77, 12288
  s_add_u32 s73, s78, 294912
  buffer_load_dwordx4 v12, s[48:51], s73 offen lds
  s_add_u32 m0, s77, 13312
  s_add_u32 s73, s78, 319488
  buffer_load_dwordx4 v12, s[48:51], s73 offen lds
  s_add_u32 m0, s77, 14336
  s_add_u32 s73, s78, 344064
  buffer_load_dwordx4 v12, s[48:51], s73 offen lds
  s_add_u32 m0, s77, 15360
  s_add_u32 s73, s78, 368640
  buffer_load_dwordx4 v12, s[48:51], s73 offen lds
  v_add_u32 v8, 98304, v55
  s_waitcnt vmcnt(16)
  ds_read_b64_tr_b16 v[24:25], v8 offset:0
  ds_read_b64_tr_b16 v[26:27], v8 offset:512
  ds_read_b64_tr_b16 v[28:29], v8 offset:64
  ds_read_b64_tr_b16 v[30:31], v8 offset:576
  s_lshl_b32 s98, s6, 16
  s_lshl_b32 s4, s7, 10
  s_add_u32 s98, s98, s4
  s_add_u32 s98, s98, 0x1400000
  s_add_u32 s99, s98, 32768
  s_waitcnt lgkmcnt(0)
  s_cmp_eq_u32 s92, 2
  s_cselect_b64 exec, -1, 0
  buffer_store_dwordx4 v[24:27], v2, s[84:87], s98 offen sc1
  buffer_store_dwordx4 v[28:31], v2, s[84:87], s99 offen sc1
  s_mov_b64 exec, -1
  s_nop 1
  s_lshr_b32 s24, s11, 2
  s_lshl_b32 s98, s2, 2
  s_add_u32 s98, s98, s92
  s_and_b32 s99, s98, 7
  s_lshr_b32 s98, s98, 3
  s_mul_i32 s25, s99, 0x38000
  s_lshl_b32 s4, s98, 10
  s_add_u32 s25, s25, s4
  s_add_u32 s25, s25, 0x1200000
  s_lshl_b32 s26, s98, 14
  s_lshl_b32 s4, s99, 7
  s_add_u32 s26, s26, s4
  s_cmp_lt_u32 s2, 224
  s_cselect_b64 s[28:29], -1, 0
  v_and_b32 v8, 31, v1
  v_lshrrev_b32 v9, 5, v1
  v_lshlrev_b32 v9, 2, v9
  v_sub_u32 v8, v8, v9
  v_mov_b32 v10, 0xf149f2ca
  v_cmp_le_i32 vcc, 0, v8
  v_cmp_le_i32 s[88:89], 1, v8
  s_nop 0
  v_cndmask_b32 v78, v10, v4, vcc
  v_cndmask_b32 v94, v4, v10, vcc
  v_cndmask_b32 v79, v10, v4, s[88:89]
  v_cndmask_b32 v95, v4, v10, s[88:89]
  v_cmp_le_i32 vcc, 2, v8
  v_cmp_le_i32 s[88:89], 3, v8
  s_nop 0
  v_cndmask_b32 v80, v10, v4, vcc
  v_cndmask_b32 v96, v4, v10, vcc
  v_cndmask_b32 v81, v10, v4, s[88:89]
  v_cndmask_b32 v97, v4, v10, s[88:89]
  v_cmp_le_i32 vcc, 8, v8
  v_cmp_le_i32 s[88:89], 9, v8
  s_nop 0
  v_cndmask_b32 v82, v10, v4, vcc
  v_cndmask_b32 v98, v4, v10, vcc
  v_cndmask_b32 v83, v10, v4, s[88:89]
  v_cndmask_b32 v99, v4, v10, s[88:89]
  v_cmp_le_i32 vcc, 10, v8
  v_cmp_le_i32 s[88:89], 11, v8
  s_nop 0
  v_cndmask_b32 v84, v10, v4, vcc
  v_cndmask_b32 v100, v4, v10, vcc
  v_cndmask_b32 v85, v10, v4, s[88:89]
  v_cndmask_b32 v101, v4, v10, s[88:89]
  v_cmp_le_i32 vcc, 16, v8
  v_cmp_le_i32 s[88:89], 17, v8
  s_nop 0
  v_cndmask_b32 v86, v10, v4, vcc
  v_cndmask_b32 v102, v4, v10, vcc
  v_cndmask_b32 v87, v10, v4, s[88:89]
  v_cndmask_b32 v103, v4, v10, s[88:89]
  v_cmp_le_i32 vcc, 18, v8
  v_cmp_le_i32 s[88:89], 19, v8
  s_nop 0
  v_cndmask_b32 v88, v10, v4, vcc
  v_cndmask_b32 v104, v4, v10, vcc
  v_cndmask_b32 v89, v10, v4, s[88:89]
  v_cndmask_b32 v105, v4, v10, s[88:89]
  v_cmp_le_i32 vcc, 24, v8
  v_cmp_le_i32 s[88:89], 25, v8
  s_nop 0
  v_cndmask_b32 v90, v10, v4, vcc
  v_cndmask_b32 v106, v4, v10, vcc
  v_cndmask_b32 v91, v10, v4, s[88:89]
  v_cndmask_b32 v107, v4, v10, s[88:89]
  v_cmp_le_i32 vcc, 26, v8
  v_cmp_le_i32 s[88:89], 27, v8
  s_nop 0
  v_cndmask_b32 v92, v10, v4, vcc
  v_cndmask_b32 v108, v4, v10, vcc
  v_cndmask_b32 v93, v10, v4, s[88:89]
  v_cndmask_b32 v109, v4, v10, s[88:89]
  v_lshrrev_b32 v8, 2, v1
  v_xor_b32 v8, v8, v1
  v_bfe_u32 v8, v8, 2, 1
  v_cmp_eq_u32 vcc, 0, v8
  v_mov_b32 v9, 0x3f803f80
  s_nop 0
  v_cndmask_b32 v24, v4, v9, vcc
  v_cndmask_b32 v25, v4, v9, vcc
  v_cndmask_b32 v26, v4, v9, vcc
  v_cndmask_b32 v27, v4, v9, vcc
  v_and_b32 v8, 0x33, v1
  v_bfe_u32 v9, v1, 2, 1
  v_lshl_add_u32 v8, v9, 3, v8
  v_bfe_u32 v9, v1, 3, 1
  v_lshl_add_u32 v8, v9, 2, v8
  v_sub_u32 v8, v8, v1
  v_lshl_add_u32 v23, v8, 4, v18
  v_lshrrev_b32 v10, 3, v1
  v_lshl_add_u32 v77, v10, 9, v12
  s_min_u32 s27, s94, 13
  s_lshl_b32 s30, s93, 2
  s_add_u32 s30, s30, s92
  s_lshl_b32 s31, s79, 16
  s_mul_i32 s4, s9, 0xc000
  s_add_u32 s31, s31, s4
  s_add_u32 s31, s31, 0x1400000
  s_xor_b32 s32, s31, 32768
  s_xor_b32 s98, s9, 1
  s_mul_i32 s33, s79, 0x38000
  s_mul_i32 s4, s9, 0x1c000
  s_add_u32 s33, s33, s4
  s_mul_i32 s4, s92, 0x7000
  s_add_u32 s33, s33, s4
  s_lshl_b32 s4, s9, 12
  s_add_u32 s33, s33, s4
  s_add_u32 s33, s33, 0x1200000
  s_mul_i32 s34, s79, 0x38000
  s_mul_i32 s4, s98, 0x1c000
  s_add_u32 s34, s34, s4
  s_mul_i32 s4, s92, 0x7000
  s_add_u32 s34, s34, s4
  s_lshl_b32 s4, s9, 12
  s_add_u32 s34, s34, s4
  s_add_u32 s34, s34, 0x1200000
  s_mul_i32 s35, s9, 0xffff9000
  s_add_u32 s35, s35, 0x2000
  s_mul_i32 s36, s98, 0xffff9000
  s_add_u32 s36, s36, 0x2000
  s_mul_i32 s37, s92, 0xe000
  s_lshl_b32 s4, s27, 8
  s_add_u32 s37, s37, s4
  v_ashrrev_i32 v8, 31, v94
  v_ashrrev_i32 v9, 31, v95
  v_alignbit_b32 v110, v9, v8, 16
  v_ashrrev_i32 v8, 31, v96
  v_ashrrev_i32 v9, 31, v97
  v_alignbit_b32 v111, v9, v8, 16
  v_ashrrev_i32 v8, 31, v98
  v_ashrrev_i32 v9, 31, v99
  v_alignbit_b32 v112, v9, v8, 16
  v_ashrrev_i32 v8, 31, v100
  v_ashrrev_i32 v9, 31, v101
  v_alignbit_b32 v113, v9, v8, 16
  v_ashrrev_i32 v8, 31, v102
  v_ashrrev_i32 v9, 31, v103
  v_alignbit_b32 v114, v9, v8, 16
  v_ashrrev_i32 v8, 31, v104
  v_ashrrev_i32 v9, 31, v105
  v_alignbit_b32 v115, v9, v8, 16
  v_ashrrev_i32 v8, 31, v106
  v_ashrrev_i32 v9, 31, v107
  v_alignbit_b32 v116, v9, v8, 16
  v_ashrrev_i32 v8, 31, v108
  v_ashrrev_i32 v9, 31, v109
  v_alignbit_b32 v117, v9, v8, 16
  v_and_b32 v8, 15, v1
  v_min_u32 v8, 2, v8
  v_lshlrev_b32 v8, 10, v8
  v_and_b32 v9, 48, v1
  v_add_u32 v8, v8, v9
  v_add_u32 v28, 156672, v8
  v_and_b32 v8, 31, v1
  v_lshrrev_b32 v9, 5, v1
  v_lshlrev_b32 v8, 6, v8
  v_lshl_add_u32 v8, v9, 4, v8
  s_lshl_b32 s99, s92, 11
  s_add_u32 s99, s99, 0x1a000
  v_add_u32 v8, s99, v8
  ds_read_b128 v[44:47], v8
  ds_read_b128 v[48:51], v8 offset:32
  s_waitcnt lgkmcnt(1)
  v_lshlrev_b32 v150, 16, v44
  v_and_b32 v151, 0xffff0000, v44
  v_lshlrev_b32 v152, 16, v45
  v_and_b32 v153, 0xffff0000, v45
  v_lshlrev_b32 v154, 16, v46
  v_and_b32 v155, 0xffff0000, v46
  v_lshlrev_b32 v156, 16, v47
  v_and_b32 v157, 0xffff0000, v47
  s_waitcnt lgkmcnt(0)
  v_lshlrev_b32 v158, 16, v48
  v_and_b32 v159, 0xffff0000, v48
  v_lshlrev_b32 v160, 16, v49
  v_and_b32 v161, 0xffff0000, v49
  v_lshlrev_b32 v162, 16, v50
  v_and_b32 v163, 0xffff0000, v50
  v_lshlrev_b32 v164, 16, v51
  v_and_b32 v165, 0xffff0000, v51
  s_movk_i32 s98, 8192
  s_movk_i32 s99, 16384
  s_movk_i32 s3, 24576
  s_mov_b32 s97, 20000
Lpoll_5:
  buffer_load_dwordx2 v[62:63], v71, s[84:87], 0 offen sc1
  buffer_load_dwordx2 v[64:65], v71, s[84:87], s98 offen sc1
  buffer_load_dwordx2 v[66:67], v71, s[84:87], s99 offen sc1
  buffer_load_dwordx2 v[68:69], v71, s[84:87], s3 offen sc1
  buffer_load_dwordx4 v[58:61], v70, s[84:87], 0 offen sc1
  s_waitcnt vmcnt(0)
  v_xor_b32_e64 v61, v3, v61
  v_bitop3_b32 v61, v61, v63, v3 bitop3:0xf6
  v_bitop3_b32 v61, v61, v65, v3 bitop3:0xf6
  v_bitop3_b32 v61, v61, v67, v3 bitop3:0xf6
  v_bitop3_b32 v61, v61, v69, v3 bitop3:0xf6
  v_cmp_ne_u32 vcc, 0, v61
  s_sub_u32 s97, s97, 1
  s_cmp_lg_u64 vcc, 0
  s_cselect_b32 s88, s97, 0
  s_cmp_lg_u32 s88, 0
  s_cbranch_scc1 Lpoll_5
  v_add_f32 v62, v62, v64
  v_add_f32 v66, v66, v68
  v_cmp_ne_u32 vcc, s5, v60
  v_add_f32 v62, v62, v66
  v_mov_b32 v60, v58
  v_cvt_pk_bf16_f32 v62, 0, v62
  v_mov_b32 v61, v59
  v_add_f32 v62, v62, v72
  v_cvt_pk_bf16_f32 v62, 0, v62
  ds_write_b32 v75, v62
  ds_read_b128 v[118:121], v74 offset:0
  ds_read_b128 v[134:137], v74 offset:128
  ds_read_b128 v[122:125], v74 offset:16
  ds_read_b128 v[138:141], v74 offset:144
  ds_read_b128 v[126:129], v74 offset:64
  ds_read_b128 v[142:145], v74 offset:192
  ds_read_b128 v[130:133], v74 offset:80
  ds_read_b128 v[146:149], v74 offset:208
  v_permlane32_swap_b32 v58, v60
  v_permlane32_swap_b32 v59, v61
  s_cmp_eq_u64 vcc, 0
  s_cselect_b32 s96, 1, 0
  v_mul_f32 v58, v58, v59
  v_pk_fma_f32 v[150:151], v[150:151], v[58:59], v[58:59] op_sel:[0,1,0] op_sel_hi:[1,1,0] neg_lo:[0,0,1] neg_hi:[0,0,1]
  v_pk_fma_f32 v[152:153], v[152:153], v[58:59], v[58:59] op_sel:[0,1,0] op_sel_hi:[1,1,0] neg_lo:[0,0,1] neg_hi:[0,0,1]
  v_pk_fma_f32 v[154:155], v[154:155], v[58:59], v[58:59] op_sel:[0,1,0] op_sel_hi:[1,1,0] neg_lo:[0,0,1] neg_hi:[0,0,1]
  v_pk_fma_f32 v[156:157], v[156:157], v[58:59], v[58:59] op_sel:[0,1,0] op_sel_hi:[1,1,0] neg_lo:[0,0,1] neg_hi:[0,0,1]
  v_pk_fma_f32 v[158:159], v[158:159], v[58:59], v[58:59] op_sel:[0,1,0] op_sel_hi:[1,1,0] neg_lo:[0,0,1] neg_hi:[0,0,1]
  v_pk_fma_f32 v[160:161], v[160:161], v[58:59], v[58:59] op_sel:[0,1,0] op_sel_hi:[1,1,0] neg_lo:[0,0,1] neg_hi:[0,0,1]
  v_pk_fma_f32 v[162:163], v[162:163], v[58:59], v[58:59] op_sel:[0,1,0] op_sel_hi:[1,1,0] neg_lo:[0,0,1] neg_hi:[0,0,1]
  v_pk_fma_f32 v[164:165], v[164:165], v[58:59], v[58:59] op_sel:[0,1,0] op_sel_hi:[1,1,0] neg_lo:[0,0,1] neg_hi:[0,0,1]
  s_waitcnt lgkmcnt(6)
  v_pk_fma_f32 v[150:151], v[150:151], v[134:135], v[118:119]
  v_pk_fma_f32 v[152:153], v[152:153], v[136:137], v[120:121]
  s_waitcnt lgkmcnt(4)
  v_pk_fma_f32 v[154:155], v[154:155], v[138:139], v[122:123]
  v_pk_fma_f32 v[156:157], v[156:157], v[140:141], v[124:125]
  s_waitcnt lgkmcnt(2)
  v_pk_fma_f32 v[158:159], v[158:159], v[142:143], v[126:127]
  v_pk_fma_f32 v[160:161], v[160:161], v[144:145], v[128:129]
  s_waitcnt lgkmcnt(0)
  v_pk_fma_f32 v[162:163], v[162:163], v[146:147], v[130:131]
  v_pk_fma_f32 v[164:165], v[164:165], v[148:149], v[132:133]
  v_cvt_pk_bf16_f32 v30, v150, v151
  v_cvt_pk_bf16_f32 v31, v152, v153
  v_cvt_pk_bf16_f32 v32, v154, v155
  v_cvt_pk_bf16_f32 v33, v156, v157
  v_cvt_pk_bf16_f32 v34, v158, v159
  v_cvt_pk_bf16_f32 v35, v160, v161
  v_cvt_pk_bf16_f32 v36, v162, v163
  v_cvt_pk_bf16_f32 v37, v164, v165
  s_cmp_eq_u32 s96, 0
  s_cbranch_scc1 Lslow_6
  buffer_store_dwordx4 v[30:33], v2, s[84:87], s91 offen
  buffer_store_dwordx4 v[34:37], v2, s[84:87], s91 offen offset:1024
Lse_7:
  s_waitcnt vmcnt(0)
  s_add_u32 s4, s74, 0x1000
  s_mov_b64 exec, 1
  s_cmp_eq_u32 s96, 0
  s_cbranch_scc1 Lslow_8
  buffer_store_dword v3, v4, s[84:87], s4 offen
Lse_9:
  s_mov_b64 exec, -1
  s_barrier
  s_add_u32 s4, s13, 0x8000
  s_cmp_eq_u32 s92, 1
  s_cselect_b64 exec, 1, 0
  buffer_store_dword v3, v4, s[84:87], s4 offen sc1
  s_mov_b64 exec, -1
  s_mul_i32 s98, s2, 0x1c00
  s_mul_i32 s4, s92, 0x700
  s_add_u32 s98, s98, s4
  s_mov_b64 exec, 0x3fff
  buffer_load_dword v5, v6, s[56:59], s98 offen
  s_mov_b64 exec, -1
  s_add_u32 m0, s24, 98304
  s_add_u32 s23, s26, 7168
  buffer_load_dwordx4 v13, s[64:67], s26 offen lds
  buffer_load_dwordx4 v13, s[64:67], s23 offen offset:1024 lds
  ds_read_b64_tr_b16 v[58:59], v56 offset:0
  ds_read_b64_tr_b16 v[60:61], v56 offset:512
  ds_read_b64_tr_b16 v[30:31], v16 offset:0
  ds_read_b64_tr_b16 v[32:33], v16 offset:512
  ds_read_b64_tr_b16 v[62:63], v56 offset:2048
  ds_read_b64_tr_b16 v[64:65], v56 offset:2560
  ds_read_b64_tr_b16 v[34:35], v16 offset:2048
  ds_read_b64_tr_b16 v[36:37], v16 offset:2560
  v_lshlrev_b32 v12, 4, v0
  v_add_u32 v12, 303104, v12
  s_lshl_b32 s98, s92, 13
  s_lshl_b32 s4, s79, 10
  s_add_u32 s98, s98, s4
  s_add_u32 s98, s98, 0x48000
  v_add_u32 v15, s98, v2
  v_and_b32_e64 v8, 3, v1
  v_bfe_u32 v9, v1, 2, 1
  v_lshl_add_u32 v8, v9, 4, v8
  v_bfe_u32 v9, v1, 3, 2
  v_lshl_add_u32 v8, v9, 2, v8
  s_lshl_b32 s98, s27, 8
  s_lshl_b32 s4, s92, 6
  s_add_u32 s98, s98, s4
  v_lshl_add_u32 v29, v8, 1, s98
  s_and_b32 s98, s22, 1023
  v_and_b32 v74, 32, v1
  v_add_u32 v74, s98, v74
  s_lshl_b32 s73, s21, 13
  s_lshl_b32 s4, s79, 10
  s_add_u32 s73, s73, s4
  s_add_u32 s73, s73, 0x80000
  s_lshl_b32 s38, s21, 6
  s_lshl_b32 s4, s79, 3
  s_add_u32 s38, s38, s4
  s_lshl_b32 s4, s9, 2
  s_add_u32 s38, s38, s4
  s_lshl_b32 s39, s93, 10
  s_lshl_b32 s4, s94, 4
  s_add_u32 s39, s39, s4
  s_lshl_b32 s4, s92, 2
  s_add_u32 s39, s39, s4
  s_add_u32 s3, s39, 49152
  s_add_u32 s91, s91, 2097152
  v_add_u32 v75, s91, v6
  s_sub_u32 s98, s73, 2048
  v_add_u32 v8, s98, v6
  v_cmp_gt_u32 vcc, 16, v1
  s_add_u32 s98, s74, 8192
  s_add_u32 s99, s38, 12288
  v_cndmask_b32 v75, v8, v75, vcc
  v_writelane_b32 v75, s98, 24
  v_writelane_b32 v75, s99, 25
  v_writelane_b32 v75, s3, 26
  s_add_u32 s3, s3, 256
  v_writelane_b32 v75, s3, 27
  s_add_u32 s3, s3, 256
  v_writelane_b32 v75, s3, 28
  s_lshl_b32 s76, s75, 11
  s_xor_b32 s76, s76, s91
  s_lshl_b32 s75, s75, 2
  s_xor_b32 s75, s75, s74
  buffer_load_ushort v70, v29, s[60:63], 0 offen
  buffer_load_dwordx4 v[42:45], v74, s[68:71], 0 offen
  buffer_load_dwordx4 v[46:49], v74, s[68:71], 0 offen offset:16
  s_movk_i32 s4, 0x1000
  s_mov_b32 s97, 20000
Lpoll_10:
  buffer_load_dword v11, v76, s[84:87], s4 offen sc1
  s_waitcnt vmcnt(0)
  v_cmp_ne_u32 vcc, s95, v11
  s_sub_u32 s97, s97, 1
  s_cmp_lg_u64 vcc, 0
  s_cselect_b32 s88, s97, 0
  s_cmp_lg_u32 s88, 0
  s_cbranch_scc1 Lpoll_10
  buffer_load_dwordx4 a[0:3], v2, s[84:87], s14 offen offset:0 sc1
  buffer_load_dwordx4 a[4:7], v2, s[84:87], s14 offen offset:1024 sc1
  buffer_load_dwordx4 a[8:11], v2, s[84:87], s14 offen offset:2048 sc1
  buffer_load_dwordx4 a[12:15], v2, s[84:87], s14 offen offset:3072 sc1
  s_add_u32 s14, s14, 4096
  buffer_load_dwordx4 a[16:19], v2, s[84:87], s14 offen offset:0 sc1
  buffer_load_dwordx4 a[20:23], v2, s[84:87], s14 offen offset:1024 sc1
  buffer_load_dwordx4 a[24:27], v2, s[84:87], s14 offen offset:2048 sc1
  buffer_load_dwordx4 a[28:31], v2, s[84:87], s14 offen offset:3072 sc1
  s_add_u32 s14, s14, 4096
  buffer_load_dwordx4 a[32:35], v2, s[84:87], s14 offen offset:0 sc1
  buffer_load_dwordx4 a[36:39], v2, s[84:87], s14 offen offset:1024 sc1
  s_add_u32 s98, s24, 98304
  v_add_u32 v55, s98, v55
  s_mov_b32 s77, 32768
  s_cmp_eq_u32 s72, 1
  s_cbranch_scc1 Lvrole_11
  s_waitcnt vmcnt(9) lgkmcnt(6)
  v_mfma_f32_32x32x16_bf16 v[130:145], v[58:61], a[0:3], 0
  ds_read_b64_tr_b16 v[66:67], v56 offset:4096
  ds_read_b64_tr_b16 v[68:69], v56 offset:4608
  buffer_load_dwordx4 a[40:43], v2, s[84:87], s14 offen offset:2048 sc1
  s_waitcnt lgkmcnt(6)
  v_mfma_f32_32x32x16_bf16 v[146:161], v[30:33], a[0:3], 0
  ds_read_b64_tr_b16 v[38:39], v16 offset:4096
  ds_read_b64_tr_b16 v[40:41], v16 offset:4608
  s_waitcnt vmcnt(9) lgkmcnt(6)
  v_mfma_f32_32x32x16_bf16 v[130:145], v[62:65], a[4:7], v[130:145]
  ds_read_b64_tr_b16 v[58:59], v56 offset:6144
  ds_read_b64_tr_b16 v[60:61], v56 offset:6656
  buffer_load_dwordx4 a[44:47], v2, s[84:87], s14 offen offset:3072 sc1
  s_add_u32 s14, s14, 4096
  s_waitcnt lgkmcnt(6)
  v_mfma_f32_32x32x16_bf16 v[146:161], v[34:37], a[4:7], v[146:161]
  ds_read_b64_tr_b16 v[30:31], v16 offset:6144
  ds_read_b64_tr_b16 v[32:33], v16 offset:6656
  s_waitcnt vmcnt(9) lgkmcnt(6)
  v_mfma_f32_32x32x16_bf16 v[130:145], v[66:69], a[8:11], v[130:145]
  ds_read_b64_tr_b16 v[62:63], v56 offset:8192
  ds_read_b64_tr_b16 v[64:65], v56 offset:8704
  buffer_load_dwordx4 a[48:51], v2, s[84:87], s14 offen offset:0 sc1
  s_waitcnt lgkmcnt(6)
  v_mfma_f32_32x32x16_bf16 v[146:161], v[38:41], a[8:11], v[146:161]
  ds_read_b64_tr_b16 v[34:35], v16 offset:8192
  ds_read_b64_tr_b16 v[36:37], v16 offset:8704
  s_waitcnt vmcnt(9) lgkmcnt(6)
  v_mfma_f32_32x32x16_bf16 v[130:145], v[58:61], a[12:15], v[130:145]
  ds_read_b64_tr_b16 v[66:67], v56 offset:10240
  ds_read_b64_tr_b16 v[68:69], v56 offset:10752
  buffer_load_dwordx4 a[52:55], v2, s[84:87], s14 offen offset:1024 sc1
  s_waitcnt lgkmcnt(6)
  v_mfma_f32_32x32x16_bf16 v[146:161], v[30:33], a[12:15], v[146:161]
  ds_read_b64_tr_b16 v[38:39], v16 offset:10240
  ds_read_b64_tr_b16 v[40:41], v16 offset:10752
  s_waitcnt vmcnt(9) lgkmcnt(6)
  v_mfma_f32_32x32x16_bf16 v[130:145], v[62:65], a[16:19], v[130:145]
  ds_read_b64_tr_b16 v[58:59], v56 offset:12288
  ds_read_b64_tr_b16 v[60:61], v56 offset:12800
  buffer_load_dwordx4 a[56:59], v2, s[84:87], s14 offen offset:2048 sc1
  s_waitcnt lgkmcnt(6)
  v_mfma_f32_32x32x16_bf16 v[146:161], v[34:37], a[16:19], v[146:161]
  ds_read_b64_tr_b16 v[30:31], v16 offset:12288
  ds_read_b64_tr_b16 v[32:33], v16 offset:12800
  s_waitcnt vmcnt(9) lgkmcnt(6)
  v_mfma_f32_32x32x16_bf16 v[130:145], v[66:69], a[20:23], v[130:145]
  ds_read_b64_tr_b16 v[62:63], v56 offset:14336
  ds_read_b64_tr_b16 v[64:65], v56 offset:14848
  buffer_load_dwordx4 a[60:63], v2, s[84:87], s14 offen offset:3072 sc1
  s_add_u32 s14, s14, 4096
  s_waitcnt lgkmcnt(6)
  v_mfma_f32_32x32x16_bf16 v[146:161], v[38:41], a[20:23], v[146:161]
  ds_read_b64_tr_b16 v[34:35], v16 offset:14336
  ds_read_b64_tr_b16 v[36:37], v16 offset:14848
  s_waitcnt vmcnt(9) lgkmcnt(6)
  v_mfma_f32_32x32x16_bf16 v[130:145], v[58:61], a[24:27], v[130:145]
  ds_read_b64_tr_b16 v[66:67], v56 offset:16384
  ds_read_b64_tr_b16 v[68:69], v56 offset:16896
  buffer_load_dwordx4 a[64:67], v2, s[84:87], s14 offen offset:0 sc1
  s_waitcnt lgkmcnt(6)
  v_mfma_f32_32x32x16_bf16 v[146:161], v[30:33], a[24:27], v[146:161]
  ds_read_b64_tr_b16 v[38:39], v16 offset:16384
  ds_read_b64_tr_b16 v[40:41], v16 offset:16896
  s_waitcnt vmcnt(9) lgkmcnt(6)
  v_mfma_f32_32x32x16_bf16 v[130:145], v[62:65], a[28:31], v[130:145]
  ds_read_b64_tr_b16 v[58:59], v56 offset:18432
  ds_read_b64_tr_b16 v[60:61], v56 offset:18944
  buffer_load_dwordx4 a[68:71], v2, s[84:87], s14 offen offset:1024 sc1
  s_waitcnt lgkmcnt(6)
  v_mfma_f32_32x32x16_bf16 v[146:161], v[34:37], a[28:31], v[146:161]
  ds_read_b64_tr_b16 v[30:31], v16 offset:18432
  ds_read_b64_tr_b16 v[32:33], v16 offset:18944
  s_waitcnt vmcnt(9) lgkmcnt(6)
  v_mfma_f32_32x32x16_bf16 v[130:145], v[66:69], a[32:35], v[130:145]
  ds_read_b64_tr_b16 v[62:63], v56 offset:20480
  ds_read_b64_tr_b16 v[64:65], v56 offset:20992
  buffer_load_dwordx4 a[72:75], v2, s[84:87], s14 offen offset:2048 sc1
  s_waitcnt lgkmcnt(6)
  v_mfma_f32_32x32x16_bf16 v[146:161], v[38:41], a[32:35], v[146:161]
  ds_read_b64_tr_b16 v[34:35], v16 offset:20480
  ds_read_b64_tr_b16 v[36:37], v16 offset:20992
  s_waitcnt vmcnt(9) lgkmcnt(6)
  v_mfma_f32_32x32x16_bf16 v[130:145], v[58:61], a[36:39], v[130:145]
  ds_read_b64_tr_b16 v[66:67], v56 offset:22528
  ds_read_b64_tr_b16 v[68:69], v56 offset:23040
  buffer_load_dwordx4 a[76:79], v2, s[84:87], s14 offen offset:3072 sc1
  s_add_u32 s14, s14, 4096
  s_waitcnt lgkmcnt(6)
  v_mfma_f32_32x32x16_bf16 v[146:161], v[30:33], a[36:39], v[146:161]
  ds_read_b64_tr_b16 v[38:39], v16 offset:22528
  ds_read_b64_tr_b16 v[40:41], v16 offset:23040
  s_waitcnt vmcnt(9) lgkmcnt(6)
  v_mfma_f32_32x32x16_bf16 v[130:145], v[62:65], a[40:43], v[130:145]
  ds_read_b64_tr_b16 v[58:59], v56 offset:24576
  ds_read_b64_tr_b16 v[60:61], v56 offset:25088
  buffer_load_dwordx4 a[80:83], v2, s[84:87], s14 offen offset:0 sc1
  s_waitcnt lgkmcnt(6)
  v_mfma_f32_32x32x16_bf16 v[146:161], v[34:37], a[40:43], v[146:161]
  ds_read_b64_tr_b16 v[30:31], v16 offset:24576
  ds_read_b64_tr_b16 v[32:33], v16 offset:25088
  s_waitcnt vmcnt(9) lgkmcnt(6)
  v_mfma_f32_32x32x16_bf16 v[130:145], v[66:69], a[44:47], v[130:145]
  ds_read_b64_tr_b16 v[62:63], v56 offset:26624
  ds_read_b64_tr_b16 v[64:65], v56 offset:27136
  buffer_load_dwordx4 a[84:87], v2, s[84:87], s14 offen offset:1024 sc1
  s_waitcnt lgkmcnt(6)
  v_mfma_f32_32x32x16_bf16 v[146:161], v[38:41], a[44:47], v[146:161]
  ds_read_b64_tr_b16 v[34:35], v16 offset:26624
  ds_read_b64_tr_b16 v[36:37], v16 offset:27136
  s_waitcnt vmcnt(9) lgkmcnt(6)
  v_mfma_f32_32x32x16_bf16 v[130:145], v[58:61], a[48:51], v[130:145]
  ds_read_b64_tr_b16 v[66:67], v56 offset:28672
  ds_read_b64_tr_b16 v[68:69], v56 offset:29184
  buffer_load_dwordx4 a[88:91], v2, s[84:87], s14 offen offset:2048 sc1
  s_waitcnt lgkmcnt(6)
  v_mfma_f32_32x32x16_bf16 v[146:161], v[30:33], a[48:51], v[146:161]
  ds_read_b64_tr_b16 v[38:39], v16 offset:28672
  ds_read_b64_tr_b16 v[40:41], v16 offset:29184
  s_waitcnt vmcnt(9) lgkmcnt(6)
  v_mfma_f32_32x32x16_bf16 v[130:145], v[62:65], a[52:55], v[130:145]
  ds_read_b64_tr_b16 v[58:59], v56 offset:30720
  ds_read_b64_tr_b16 v[60:61], v56 offset:31232
  buffer_load_dwordx4 a[92:95], v2, s[84:87], s14 offen offset:3072 sc1
  s_add_u32 s14, s14, 4096
  s_waitcnt lgkmcnt(6)
  v_mfma_f32_32x32x16_bf16 v[146:161], v[34:37], a[52:55], v[146:161]
  ds_read_b64_tr_b16 v[30:31], v16 offset:30720
  ds_read_b64_tr_b16 v[32:33], v16 offset:31232
  s_waitcnt vmcnt(9) lgkmcnt(6)
  v_mfma_f32_32x32x16_bf16 v[130:145], v[66:69], a[56:59], v[130:145]
  ds_read_b64_tr_b16 v[62:63], v56 offset:32768
  ds_read_b64_tr_b16 v[64:65], v56 offset:33280
  buffer_load_dwordx4 a[96:99], v2, s[84:87], s14 offen offset:0 sc1
  s_waitcnt lgkmcnt(6)
  v_mfma_f32_32x32x16_bf16 v[146:161], v[38:41], a[56:59], v[146:161]
  ds_read_b64_tr_b16 v[34:35], v16 offset:32768
  ds_read_b64_tr_b16 v[36:37], v16 offset:33280
  s_waitcnt vmcnt(9) lgkmcnt(6)
  v_mfma_f32_32x32x16_bf16 v[130:145], v[58:61], a[60:63], v[130:145]
  ds_read_b64_tr_b16 v[66:67], v56 offset:34816
  ds_read_b64_tr_b16 v[68:69], v56 offset:35328
  buffer_load_dwordx4 a[100:103], v2, s[84:87], s14 offen offset:1024 sc1
  s_waitcnt lgkmcnt(6)
  v_mfma_f32_32x32x16_bf16 v[146:161], v[30:33], a[60:63], v[146:161]
  ds_read_b64_tr_b16 v[38:39], v16 offset:34816
  ds_read_b64_tr_b16 v[40:41], v16 offset:35328
  s_waitcnt vmcnt(9) lgkmcnt(6)
  v_mfma_f32_32x32x16_bf16 v[130:145], v[62:65], a[64:67], v[130:145]
  ds_read_b64_tr_b16 v[58:59], v56 offset:36864
  ds_read_b64_tr_b16 v[60:61], v56 offset:37376
  buffer_load_dwordx4 a[104:107], v2, s[84:87], s14 offen offset:2048 sc1
  s_waitcnt lgkmcnt(6)
  v_mfma_f32_32x32x16_bf16 v[146:161], v[34:37], a[64:67], v[146:161]
  ds_read_b64_tr_b16 v[30:31], v16 offset:36864
  ds_read_b64_tr_b16 v[32:33], v16 offset:37376
  s_waitcnt vmcnt(9) lgkmcnt(6)
  v_mfma_f32_32x32x16_bf16 v[130:145], v[66:69], a[68:71], v[130:145]
  ds_read_b64_tr_b16 v[62:63], v56 offset:38912
  ds_read_b64_tr_b16 v[64:65], v56 offset:39424
  buffer_load_dwordx4 a[108:111], v2, s[84:87], s14 offen offset:3072 sc1
  s_add_u32 s14, s14, 4096
  s_waitcnt lgkmcnt(6)
  v_mfma_f32_32x32x16_bf16 v[146:161], v[38:41], a[68:71], v[146:161]
  ds_read_b64_tr_b16 v[34:35], v16 offset:38912
  ds_read_b64_tr_b16 v[36:37], v16 offset:39424
  s_waitcnt vmcnt(9) lgkmcnt(6)
  v_mfma_f32_32x32x16_bf16 v[130:145], v[58:61], a[72:75], v[130:145]
  ds_read_b64_tr_b16 v[66:67], v56 offset:40960
  ds_read_b64_tr_b16 v[68:69], v56 offset:41472
  buffer_load_dwordx4 a[112:115], v2, s[84:87], s14 offen offset:0 sc1
  s_waitcnt lgkmcnt(6)
  v_mfma_f32_32x32x16_bf16 v[146:161], v[30:33], a[72:75], v[146:161]
  ds_read_b64_tr_b16 v[38:39], v16 offset:40960
  ds_read_b64_tr_b16 v[40:41], v16 offset:41472
  s_waitcnt vmcnt(9) lgkmcnt(6)
  v_mfma_f32_32x32x16_bf16 v[130:145], v[62:65], a[76:79], v[130:145]
  ds_read_b64_tr_b16 v[58:59], v56 offset:43008
  ds_read_b64_tr_b16 v[60:61], v56 offset:43520
  buffer_load_dwordx4 a[116:119], v2, s[84:87], s14 offen offset:1024 sc1
  s_waitcnt lgkmcnt(6)
  v_mfma_f32_32x32x16_bf16 v[146:161], v[34:37], a[76:79], v[146:161]
  ds_read_b64_tr_b16 v[30:31], v16 offset:43008
  ds_read_b64_tr_b16 v[32:33], v16 offset:43520
  s_waitcnt vmcnt(9) lgkmcnt(6)
  v_mfma_f32_32x32x16_bf16 v[130:145], v[66:69], a[80:83], v[130:145]
  ds_read_b64_tr_b16 v[62:63], v56 offset:45056
  ds_read_b64_tr_b16 v[64:65], v56 offset:45568
  buffer_load_dwordx4 a[120:123], v2, s[84:87], s14 offen offset:2048 sc1
  s_waitcnt lgkmcnt(6)
  v_mfma_f32_32x32x16_bf16 v[146:161], v[38:41], a[80:83], v[146:161]
  ds_read_b64_tr_b16 v[34:35], v16 offset:45056
  ds_read_b64_tr_b16 v[36:37], v16 offset:45568
  s_waitcnt vmcnt(9) lgkmcnt(6)
  v_mfma_f32_32x32x16_bf16 v[130:145], v[58:61], a[84:87], v[130:145]
  ds_read_b64_tr_b16 v[66:67], v56 offset:47104
  ds_read_b64_tr_b16 v[68:69], v56 offset:47616
  buffer_load_dwordx4 a[124:127], v2, s[84:87], s14 offen offset:3072 sc1
  s_waitcnt lgkmcnt(6)
  v_mfma_f32_32x32x16_bf16 v[146:161], v[30:33], a[84:87], v[146:161]
  ds_read_b64_tr_b16 v[38:39], v16 offset:47104
  ds_read_b64_tr_b16 v[40:41], v16 offset:47616
  s_waitcnt vmcnt(9) lgkmcnt(6)
  v_mfma_f32_32x32x16_bf16 v[130:145], v[62:65], a[88:91], v[130:145]
  ds_read_b64_tr_b16 v[58:59], v56 offset:49152
  ds_read_b64_tr_b16 v[60:61], v56 offset:49664
  s_mov_b64 exec, 0xffff
  buffer_load_dword v5, v22, s[48:51], 0 offen
  s_mov_b64 exec, -1
  s_waitcnt lgkmcnt(6)
  v_mfma_f32_32x32x16_bf16 v[146:161], v[34:37], a[88:91], v[146:161]
  ds_read_b64_tr_b16 v[30:31], v16 offset:49152
  ds_read_b64_tr_b16 v[32:33], v16 offset:49664
  s_waitcnt vmcnt(9) lgkmcnt(6)
  v_mfma_f32_32x32x16_bf16 v[130:145], v[66:69], a[92:95], v[130:145]
  ds_read_b64_tr_b16 v[62:63], v56 offset:51200
  ds_read_b64_tr_b16 v[64:65], v56 offset:51712
  buffer_load_dwordx4 v[126:129], v2, s[84:87], s77 offen sc1
  s_waitcnt lgkmcnt(6)
  v_mfma_f32_32x32x16_bf16 v[146:161], v[38:41], a[92:95], v[146:161]
  ds_read_b64_tr_b16 v[34:35], v16 offset:51200
  ds_read_b64_tr_b16 v[36:37], v16 offset:51712
  s_waitcnt vmcnt(9) lgkmcnt(6)
  v_mfma_f32_32x32x16_bf16 v[130:145], v[58:61], a[96:99], v[130:145]
  ds_read_b64_tr_b16 v[66:67], v56 offset:53248
  ds_read_b64_tr_b16 v[68:69], v56 offset:53760
  s_waitcnt lgkmcnt(6)
  v_mfma_f32_32x32x16_bf16 v[146:161], v[30:33], a[96:99], v[146:161]
  ds_read_b64_tr_b16 v[38:39], v16 offset:53248
  ds_read_b64_tr_b16 v[40:41], v16 offset:53760
  s_waitcnt vmcnt(8) lgkmcnt(6)
  v_mfma_f32_32x32x16_bf16 v[130:145], v[62:65], a[100:103], v[130:145]
  ds_read_b64_tr_b16 v[58:59], v56 offset:55296
  ds_read_b64_tr_b16 v[60:61], v56 offset:55808
  s_waitcnt lgkmcnt(6)
  v_mfma_f32_32x32x16_bf16 v[146:161], v[34:37], a[100:103], v[146:161]
  ds_read_b64_tr_b16 v[30:31], v16 offset:55296
  ds_read_b64_tr_b16 v[32:33], v16 offset:55808
  s_waitcnt vmcnt(7) lgkmcnt(6)
  v_mfma_f32_32x32x16_bf16 v[130:145], v[66:69], a[104:107], v[130:145]
  ds_read_b64_tr_b16 v[62:63], v56 offset:57344
  ds_read_b64_tr_b16 v[64:65], v56 offset:57856
  s_waitcnt lgkmcnt(6)
  v_mfma_f32_32x32x16_bf16 v[146:161], v[38:41], a[104:107], v[146:161]
  ds_read_b64_tr_b16 v[34:35], v16 offset:57344
  ds_read_b64_tr_b16 v[36:37], v16 offset:57856
  s_waitcnt vmcnt(6) lgkmcnt(6)
  v_mfma_f32_32x32x16_bf16 v[130:145], v[58:61], a[108:111], v[130:145]
  ds_read_b64_tr_b16 v[66:67], v56 offset:59392
  ds_read_b64_tr_b16 v[68:69], v56 offset:59904
  s_mov_b32 exec_lo, 0xffff0000
  s_mov_b32 exec_hi, 0
  buffer_load_dword v5, v22, s[48:51], 0 offen
  s_mov_b64 exec, -1
  s_waitcnt lgkmcnt(6)
  v_mfma_f32_32x32x16_bf16 v[146:161], v[30:33], a[108:111], v[146:161]
  ds_read_b64_tr_b16 v[38:39], v16 offset:59392
  ds_read_b64_tr_b16 v[40:41], v16 offset:59904
  s_waitcnt vmcnt(6) lgkmcnt(6)
  v_mfma_f32_32x32x16_bf16 v[130:145], v[62:65], a[112:115], v[130:145]
  ds_read_b64_tr_b16 v[58:59], v56 offset:61440
  ds_read_b64_tr_b16 v[60:61], v56 offset:61952
  s_waitcnt lgkmcnt(6)
  v_mfma_f32_32x32x16_bf16 v[146:161], v[34:37], a[112:115], v[146:161]
  ds_read_b64_tr_b16 v[30:31], v16 offset:61440
  ds_read_b64_tr_b16 v[32:33], v16 offset:61952
  s_waitcnt vmcnt(5) lgkmcnt(6)
  v_mfma_f32_32x32x16_bf16 v[130:145], v[66:69], a[116:119], v[130:145]
  ds_read_b64_tr_b16 v[62:63], v56 offset:63488
  ds_read_b64_tr_b16 v[64:65], v56 offset:64000
  s_waitcnt lgkmcnt(6)
  v_mfma_f32_32x32x16_bf16 v[146:161], v[38:41], a[116:119], v[146:161]
  ds_read_b64_tr_b16 v[34:35], v16 offset:63488
  ds_read_b64_tr_b16 v[36:37], v16 offset:64000
  s_waitcnt vmcnt(4) lgkmcnt(6)
  v_mfma_f32_32x32x16_bf16 v[130:145], v[58:61], a[120:123], v[130:145]
  s_waitcnt lgkmcnt(4)
  v_mfma_f32_32x32x16_bf16 v[146:161], v[30:33], a[120:123], v[146:161]
  s_waitcnt vmcnt(3) lgkmcnt(2)
  v_mfma_f32_32x32x16_bf16 v[130:145], v[62:65], a[124:127], v[130:145]
  s_waitcnt lgkmcnt(0)
  v_mfma_f32_32x32x16_bf16 v[146:161], v[34:37], a[124:127], v[146:161]
  s_branch L_12
Lvrole_11:
  s_waitcnt vmcnt(9) lgkmcnt(6)
  v_mfma_f32_32x32x16_bf16 v[130:145], a[0:3], v[58:61], 0
  ds_read_b64_tr_b16 v[66:67], v56 offset:4096
  ds_read_b64_tr_b16 v[68:69], v56 offset:4608
  buffer_load_dwordx4 a[40:43], v2, s[84:87], s14 offen offset:2048 sc1
  s_waitcnt lgkmcnt(6)
  v_mfma_f32_32x32x16_bf16 v[146:161], a[0:3], v[30:33], 0
  ds_read_b64_tr_b16 v[38:39], v16 offset:4096
  ds_read_b64_tr_b16 v[40:41], v16 offset:4608
  s_waitcnt vmcnt(9) lgkmcnt(6)
  v_mfma_f32_32x32x16_bf16 v[130:145], a[4:7], v[62:65], v[130:145]
  ds_read_b64_tr_b16 v[58:59], v56 offset:6144
  ds_read_b64_tr_b16 v[60:61], v56 offset:6656
  buffer_load_dwordx4 a[44:47], v2, s[84:87], s14 offen offset:3072 sc1
  s_add_u32 s14, s14, 4096
  s_waitcnt lgkmcnt(6)
  v_mfma_f32_32x32x16_bf16 v[146:161], a[4:7], v[34:37], v[146:161]
  ds_read_b64_tr_b16 v[30:31], v16 offset:6144
  ds_read_b64_tr_b16 v[32:33], v16 offset:6656
  s_waitcnt vmcnt(9) lgkmcnt(6)
  v_mfma_f32_32x32x16_bf16 v[130:145], a[8:11], v[66:69], v[130:145]
  ds_read_b64_tr_b16 v[62:63], v56 offset:8192
  ds_read_b64_tr_b16 v[64:65], v56 offset:8704
  buffer_load_dwordx4 a[48:51], v2, s[84:87], s14 offen offset:0 sc1
  s_waitcnt lgkmcnt(6)
  v_mfma_f32_32x32x16_bf16 v[146:161], a[8:11], v[38:41], v[146:161]
  ds_read_b64_tr_b16 v[34:35], v16 offset:8192
  ds_read_b64_tr_b16 v[36:37], v16 offset:8704
  s_waitcnt vmcnt(9) lgkmcnt(6)
  v_mfma_f32_32x32x16_bf16 v[130:145], a[12:15], v[58:61], v[130:145]
  ds_read_b64_tr_b16 v[66:67], v56 offset:10240
  ds_read_b64_tr_b16 v[68:69], v56 offset:10752
  buffer_load_dwordx4 a[52:55], v2, s[84:87], s14 offen offset:1024 sc1
  s_waitcnt lgkmcnt(6)
  v_mfma_f32_32x32x16_bf16 v[146:161], a[12:15], v[30:33], v[146:161]
  ds_read_b64_tr_b16 v[38:39], v16 offset:10240
  ds_read_b64_tr_b16 v[40:41], v16 offset:10752
  s_waitcnt vmcnt(9) lgkmcnt(6)
  v_mfma_f32_32x32x16_bf16 v[130:145], a[16:19], v[62:65], v[130:145]
  ds_read_b64_tr_b16 v[58:59], v56 offset:12288
  ds_read_b64_tr_b16 v[60:61], v56 offset:12800
  buffer_load_dwordx4 a[56:59], v2, s[84:87], s14 offen offset:2048 sc1
  s_waitcnt lgkmcnt(6)
  v_mfma_f32_32x32x16_bf16 v[146:161], a[16:19], v[34:37], v[146:161]
  ds_read_b64_tr_b16 v[30:31], v16 offset:12288
  ds_read_b64_tr_b16 v[32:33], v16 offset:12800
  s_waitcnt vmcnt(9) lgkmcnt(6)
  v_mfma_f32_32x32x16_bf16 v[130:145], a[20:23], v[66:69], v[130:145]
  ds_read_b64_tr_b16 v[62:63], v56 offset:14336
  ds_read_b64_tr_b16 v[64:65], v56 offset:14848
  buffer_load_dwordx4 a[60:63], v2, s[84:87], s14 offen offset:3072 sc1
  s_add_u32 s14, s14, 4096
  s_waitcnt lgkmcnt(6)
  v_mfma_f32_32x32x16_bf16 v[146:161], a[20:23], v[38:41], v[146:161]
  ds_read_b64_tr_b16 v[34:35], v16 offset:14336
  ds_read_b64_tr_b16 v[36:37], v16 offset:14848
  s_waitcnt vmcnt(9) lgkmcnt(6)
  v_mfma_f32_32x32x16_bf16 v[130:145], a[24:27], v[58:61], v[130:145]
  ds_read_b64_tr_b16 v[66:67], v56 offset:16384
  ds_read_b64_tr_b16 v[68:69], v56 offset:16896
  buffer_load_dwordx4 a[64:67], v2, s[84:87], s14 offen offset:0 sc1
  s_waitcnt lgkmcnt(6)
  v_mfma_f32_32x32x16_bf16 v[146:161], a[24:27], v[30:33], v[146:161]
  ds_read_b64_tr_b16 v[38:39], v16 offset:16384
  ds_read_b64_tr_b16 v[40:41], v16 offset:16896
  s_waitcnt vmcnt(9) lgkmcnt(6)
  v_mfma_f32_32x32x16_bf16 v[130:145], a[28:31], v[62:65], v[130:145]
  ds_read_b64_tr_b16 v[58:59], v56 offset:18432
  ds_read_b64_tr_b16 v[60:61], v56 offset:18944
  buffer_load_dwordx4 a[68:71], v2, s[84:87], s14 offen offset:1024 sc1
  s_waitcnt lgkmcnt(6)
  v_mfma_f32_32x32x16_bf16 v[146:161], a[28:31], v[34:37], v[146:161]
  ds_read_b64_tr_b16 v[30:31], v16 offset:18432
  ds_read_b64_tr_b16 v[32:33], v16 offset:18944
  s_waitcnt vmcnt(9) lgkmcnt(6)
  v_mfma_f32_32x32x16_bf16 v[130:145], a[32:35], v[66:69], v[130:145]
  ds_read_b64_tr_b16 v[62:63], v56 offset:20480
  ds_read_b64_tr_b16 v[64:65], v56 offset:20992
  buffer_load_dwordx4 a[72:75], v2, s[84:87], s14 offen offset:2048 sc1
  s_waitcnt lgkmcnt(6)
  v_mfma_f32_32x32x16_bf16 v[146:161], a[32:35], v[38:41], v[146:161]
  ds_read_b64_tr_b16 v[34:35], v16 offset:20480
  ds_read_b64_tr_b16 v[36:37], v16 offset:20992
  s_waitcnt vmcnt(9) lgkmcnt(6)
  v_mfma_f32_32x32x16_bf16 v[130:145], a[36:39], v[58:61], v[130:145]
  ds_read_b64_tr_b16 v[66:67], v56 offset:22528
  ds_read_b64_tr_b16 v[68:69], v56 offset:23040
  buffer_load_dwordx4 a[76:79], v2, s[84:87], s14 offen offset:3072 sc1
  s_add_u32 s14, s14, 4096
  s_waitcnt lgkmcnt(6)
  v_mfma_f32_32x32x16_bf16 v[146:161], a[36:39], v[30:33], v[146:161]
  ds_read_b64_tr_b16 v[38:39], v16 offset:22528
  ds_read_b64_tr_b16 v[40:41], v16 offset:23040
  s_waitcnt vmcnt(9) lgkmcnt(6)
  v_mfma_f32_32x32x16_bf16 v[130:145], a[40:43], v[62:65], v[130:145]
  ds_read_b64_tr_b16 v[58:59], v56 offset:24576
  ds_read_b64_tr_b16 v[60:61], v56 offset:25088
  buffer_load_dwordx4 a[80:83], v2, s[84:87], s14 offen offset:0 sc1
  s_waitcnt lgkmcnt(6)
  v_mfma_f32_32x32x16_bf16 v[146:161], a[40:43], v[34:37], v[146:161]
  ds_read_b64_tr_b16 v[30:31], v16 offset:24576
  ds_read_b64_tr_b16 v[32:33], v16 offset:25088
  s_waitcnt vmcnt(9) lgkmcnt(6)
  v_mfma_f32_32x32x16_bf16 v[130:145], a[44:47], v[66:69], v[130:145]
  ds_read_b64_tr_b16 v[62:63], v56 offset:26624
  ds_read_b64_tr_b16 v[64:65], v56 offset:27136
  buffer_load_dwordx4 a[84:87], v2, s[84:87], s14 offen offset:1024 sc1
  s_waitcnt lgkmcnt(6)
  v_mfma_f32_32x32x16_bf16 v[146:161], a[44:47], v[38:41], v[146:161]
  ds_read_b64_tr_b16 v[34:35], v16 offset:26624
  ds_read_b64_tr_b16 v[36:37], v16 offset:27136
  s_waitcnt vmcnt(9) lgkmcnt(6)
  v_mfma_f32_32x32x16_bf16 v[130:145], a[48:51], v[58:61], v[130:145]
  ds_read_b64_tr_b16 v[66:67], v56 offset:28672
  ds_read_b64_tr_b16 v[68:69], v56 offset:29184
  buffer_load_dwordx4 a[88:91], v2, s[84:87], s14 offen offset:2048 sc1
  s_waitcnt lgkmcnt(6)
  v_mfma_f32_32x32x16_bf16 v[146:161], a[48:51], v[30:33], v[146:161]
  ds_read_b64_tr_b16 v[38:39], v16 offset:28672
  ds_read_b64_tr_b16 v[40:41], v16 offset:29184
  s_waitcnt vmcnt(9) lgkmcnt(6)
  v_mfma_f32_32x32x16_bf16 v[130:145], a[52:55], v[62:65], v[130:145]
  ds_read_b64_tr_b16 v[58:59], v56 offset:30720
  ds_read_b64_tr_b16 v[60:61], v56 offset:31232
  buffer_load_dwordx4 a[92:95], v2, s[84:87], s14 offen offset:3072 sc1
  s_add_u32 s14, s14, 4096
  s_waitcnt lgkmcnt(6)
  v_mfma_f32_32x32x16_bf16 v[146:161], a[52:55], v[34:37], v[146:161]
  ds_read_b64_tr_b16 v[30:31], v16 offset:30720
  ds_read_b64_tr_b16 v[32:33], v16 offset:31232
  s_waitcnt vmcnt(9) lgkmcnt(6)
  v_mfma_f32_32x32x16_bf16 v[130:145], a[56:59], v[66:69], v[130:145]
  ds_read_b64_tr_b16 v[62:63], v56 offset:32768
  ds_read_b64_tr_b16 v[64:65], v56 offset:33280
  buffer_load_dwordx4 a[96:99], v2, s[84:87], s14 offen offset:0 sc1
  s_waitcnt lgkmcnt(6)
  v_mfma_f32_32x32x16_bf16 v[146:161], a[56:59], v[38:41], v[146:161]
  ds_read_b64_tr_b16 v[34:35], v16 offset:32768
  ds_read_b64_tr_b16 v[36:37], v16 offset:33280
  s_waitcnt vmcnt(9) lgkmcnt(6)
  v_mfma_f32_32x32x16_bf16 v[130:145], a[60:63], v[58:61], v[130:145]
  ds_read_b64_tr_b16 v[66:67], v56 offset:34816
  ds_read_b64_tr_b16 v[68:69], v56 offset:35328
  buffer_load_dwordx4 a[100:103], v2, s[84:87], s14 offen offset:1024 sc1
  s_waitcnt lgkmcnt(6)
  v_mfma_f32_32x32x16_bf16 v[146:161], a[60:63], v[30:33], v[146:161]
  ds_read_b64_tr_b16 v[38:39], v16 offset:34816
  ds_read_b64_tr_b16 v[40:41], v16 offset:35328
  s_waitcnt vmcnt(9) lgkmcnt(6)
  v_mfma_f32_32x32x16_bf16 v[130:145], a[64:67], v[62:65], v[130:145]
  ds_read_b64_tr_b16 v[58:59], v56 offset:36864
  ds_read_b64_tr_b16 v[60:61], v56 offset:37376
  buffer_load_dwordx4 a[104:107], v2, s[84:87], s14 offen offset:2048 sc1
  s_waitcnt lgkmcnt(6)
  v_mfma_f32_32x32x16_bf16 v[146:161], a[64:67], v[34:37], v[146:161]
  ds_read_b64_tr_b16 v[30:31], v16 offset:36864
  ds_read_b64_tr_b16 v[32:33], v16 offset:37376
  s_waitcnt vmcnt(9) lgkmcnt(6)
  v_mfma_f32_32x32x16_bf16 v[130:145], a[68:71], v[66:69], v[130:145]
  ds_read_b64_tr_b16 v[62:63], v56 offset:38912
  ds_read_b64_tr_b16 v[64:65], v56 offset:39424
  buffer_load_dwordx4 a[108:111], v2, s[84:87], s14 offen offset:3072 sc1
  s_add_u32 s14, s14, 4096
  s_waitcnt lgkmcnt(6)
  v_mfma_f32_32x32x16_bf16 v[146:161], a[68:71], v[38:41], v[146:161]
  ds_read_b64_tr_b16 v[34:35], v16 offset:38912
  ds_read_b64_tr_b16 v[36:37], v16 offset:39424
  s_waitcnt vmcnt(9) lgkmcnt(6)
  v_mfma_f32_32x32x16_bf16 v[130:145], a[72:75], v[58:61], v[130:145]
  ds_read_b64_tr_b16 v[66:67], v56 offset:40960
  ds_read_b64_tr_b16 v[68:69], v56 offset:41472
  buffer_load_dwordx4 a[112:115], v2, s[84:87], s14 offen offset:0 sc1
  s_waitcnt lgkmcnt(6)
  v_mfma_f32_32x32x16_bf16 v[146:161], a[72:75], v[30:33], v[146:161]
  ds_read_b64_tr_b16 v[38:39], v16 offset:40960
  ds_read_b64_tr_b16 v[40:41], v16 offset:41472
  s_waitcnt vmcnt(9) lgkmcnt(6)
  v_mfma_f32_32x32x16_bf16 v[130:145], a[76:79], v[62:65], v[130:145]
  ds_read_b64_tr_b16 v[58:59], v56 offset:43008
  ds_read_b64_tr_b16 v[60:61], v56 offset:43520
  buffer_load_dwordx4 a[116:119], v2, s[84:87], s14 offen offset:1024 sc1
  s_waitcnt lgkmcnt(6)
  v_mfma_f32_32x32x16_bf16 v[146:161], a[76:79], v[34:37], v[146:161]
  ds_read_b64_tr_b16 v[30:31], v16 offset:43008
  ds_read_b64_tr_b16 v[32:33], v16 offset:43520
  s_waitcnt vmcnt(9) lgkmcnt(6)
  v_mfma_f32_32x32x16_bf16 v[130:145], a[80:83], v[66:69], v[130:145]
  ds_read_b64_tr_b16 v[62:63], v56 offset:45056
  ds_read_b64_tr_b16 v[64:65], v56 offset:45568
  buffer_load_dwordx4 a[120:123], v2, s[84:87], s14 offen offset:2048 sc1
  s_waitcnt lgkmcnt(6)
  v_mfma_f32_32x32x16_bf16 v[146:161], a[80:83], v[38:41], v[146:161]
  ds_read_b64_tr_b16 v[34:35], v16 offset:45056
  ds_read_b64_tr_b16 v[36:37], v16 offset:45568
  s_waitcnt vmcnt(9) lgkmcnt(6)
  v_mfma_f32_32x32x16_bf16 v[130:145], a[84:87], v[58:61], v[130:145]
  ds_read_b64_tr_b16 v[66:67], v56 offset:47104
  ds_read_b64_tr_b16 v[68:69], v56 offset:47616
  buffer_load_dwordx4 a[124:127], v2, s[84:87], s14 offen offset:3072 sc1
  s_waitcnt lgkmcnt(6)
  v_mfma_f32_32x32x16_bf16 v[146:161], a[84:87], v[30:33], v[146:161]
  ds_read_b64_tr_b16 v[38:39], v16 offset:47104
  ds_read_b64_tr_b16 v[40:41], v16 offset:47616
  s_waitcnt vmcnt(9) lgkmcnt(6)
  v_mfma_f32_32x32x16_bf16 v[130:145], a[88:91], v[62:65], v[130:145]
  ds_read_b64_tr_b16 v[58:59], v56 offset:49152
  ds_read_b64_tr_b16 v[60:61], v56 offset:49664
  s_mov_b64 exec, 0xffff
  buffer_load_dword v5, v22, s[48:51], 0 offen
  s_mov_b64 exec, -1
  s_waitcnt lgkmcnt(6)
  v_mfma_f32_32x32x16_bf16 v[146:161], a[88:91], v[34:37], v[146:161]
  ds_read_b64_tr_b16 v[30:31], v16 offset:49152
  ds_read_b64_tr_b16 v[32:33], v16 offset:49664
  s_waitcnt vmcnt(9) lgkmcnt(6)
  v_mfma_f32_32x32x16_bf16 v[130:145], a[92:95], v[66:69], v[130:145]
  ds_read_b64_tr_b16 v[62:63], v56 offset:51200
  ds_read_b64_tr_b16 v[64:65], v56 offset:51712
  buffer_load_dwordx4 v[126:129], v2, s[84:87], s77 offen sc1
  s_waitcnt lgkmcnt(6)
  v_mfma_f32_32x32x16_bf16 v[146:161], a[92:95], v[38:41], v[146:161]
  ds_read_b64_tr_b16 v[34:35], v16 offset:51200
  ds_read_b64_tr_b16 v[36:37], v16 offset:51712
  s_waitcnt vmcnt(9) lgkmcnt(6)
  v_mfma_f32_32x32x16_bf16 v[130:145], a[96:99], v[58:61], v[130:145]
  ds_read_b64_tr_b16 v[66:67], v56 offset:53248
  ds_read_b64_tr_b16 v[68:69], v56 offset:53760
  s_waitcnt lgkmcnt(6)
  v_mfma_f32_32x32x16_bf16 v[146:161], a[96:99], v[30:33], v[146:161]
  ds_read_b64_tr_b16 v[38:39], v16 offset:53248
  ds_read_b64_tr_b16 v[40:41], v16 offset:53760
  s_waitcnt vmcnt(8) lgkmcnt(6)
  v_mfma_f32_32x32x16_bf16 v[130:145], a[100:103], v[62:65], v[130:145]
  ds_read_b64_tr_b16 v[58:59], v56 offset:55296
  ds_read_b64_tr_b16 v[60:61], v56 offset:55808
  s_waitcnt lgkmcnt(6)
  v_mfma_f32_32x32x16_bf16 v[146:161], a[100:103], v[34:37], v[146:161]
  ds_read_b64_tr_b16 v[30:31], v16 offset:55296
  ds_read_b64_tr_b16 v[32:33], v16 offset:55808
  s_waitcnt vmcnt(7) lgkmcnt(6)
  v_mfma_f32_32x32x16_bf16 v[130:145], a[104:107], v[66:69], v[130:145]
  ds_read_b64_tr_b16 v[62:63], v56 offset:57344
  ds_read_b64_tr_b16 v[64:65], v56 offset:57856
  s_waitcnt lgkmcnt(6)
  v_mfma_f32_32x32x16_bf16 v[146:161], a[104:107], v[38:41], v[146:161]
  ds_read_b64_tr_b16 v[34:35], v16 offset:57344
  ds_read_b64_tr_b16 v[36:37], v16 offset:57856
  s_waitcnt vmcnt(6) lgkmcnt(6)
  v_mfma_f32_32x32x16_bf16 v[130:145], a[108:111], v[58:61], v[130:145]
  ds_read_b64_tr_b16 v[66:67], v56 offset:59392
  ds_read_b64_tr_b16 v[68:69], v56 offset:59904
  s_mov_b32 exec_lo, 0xffff0000
  s_mov_b32 exec_hi, 0
  buffer_load_dword v5, v22, s[48:51], 0 offen
  s_mov_b64 exec, -1
  s_waitcnt lgkmcnt(6)
  v_mfma_f32_32x32x16_bf16 v[146:161], a[108:111], v[30:33], v[146:161]
  ds_read_b64_tr_b16 v[38:39], v16 offset:59392
  ds_read_b64_tr_b16 v[40:41], v16 offset:59904
  s_waitcnt vmcnt(6) lgkmcnt(6)
  v_mfma_f32_32x32x16_bf16 v[130:145], a[112:115], v[62:65], v[130:145]
  ds_read_b64_tr_b16 v[58:59], v56 offset:61440
  ds_read_b64_tr_b16 v[60:61], v56 offset:61952
  s_waitcnt lgkmcnt(6)
  v_mfma_f32_32x32x16_bf16 v[146:161], a[112:115], v[34:37], v[146:161]
  ds_read_b64_tr_b16 v[30:31], v16 offset:61440
  ds_read_b64_tr_b16 v[32:33], v16 offset:61952
  s_waitcnt vmcnt(5) lgkmcnt(6)
  v_mfma_f32_32x32x16_bf16 v[130:145], a[116:119], v[66:69], v[130:145]
  ds_read_b64_tr_b16 v[62:63], v56 offset:63488
  ds_read_b64_tr_b16 v[64:65], v56 offset:64000
  s_waitcnt lgkmcnt(6)
  v_mfma_f32_32x32x16_bf16 v[146:161], a[116:119], v[38:41], v[146:161]
  ds_read_b64_tr_b16 v[34:35], v16 offset:63488
  ds_read_b64_tr_b16 v[36:37], v16 offset:64000
  s_waitcnt vmcnt(4) lgkmcnt(6)
  v_mfma_f32_32x32x16_bf16 v[130:145], a[120:123], v[58:61], v[130:145]
  s_waitcnt lgkmcnt(4)
  v_mfma_f32_32x32x16_bf16 v[146:161], a[120:123], v[30:33], v[146:161]
  s_waitcnt vmcnt(3) lgkmcnt(2)
  v_mfma_f32_32x32x16_bf16 v[130:145], a[124:127], v[62:65], v[130:145]
  s_waitcnt lgkmcnt(0)
  v_mfma_f32_32x32x16_bf16 v[146:161], a[124:127], v[34:37], v[146:161]
L_12:
  s_nop 9
  v_cvt_pk_bf16_f32 v194, v130, v131
  v_cvt_pk_bf16_f32 v195, v132, v133
  v_cvt_pk_bf16_f32 v196, v134, v135
  v_cvt_pk_bf16_f32 v197, v136, v137
  buffer_store_dwordx4 v[194:197], v2, s[84:87], s16 offen offset:0 sc1
  v_cvt_pk_bf16_f32 v198, v138, v139
  v_cvt_pk_bf16_f32 v199, v140, v141
  v_cvt_pk_bf16_f32 v200, v142, v143
  v_cvt_pk_bf16_f32 v201, v144, v145
  buffer_store_dwordx4 v[198:201], v2, s[84:87], s16 offen offset:1024 sc1
  v_cvt_pk_bf16_f32 v202, v146, v147
  v_cvt_pk_bf16_f32 v203, v148, v149
  v_cvt_pk_bf16_f32 v204, v150, v151
  v_cvt_pk_bf16_f32 v205, v152, v153
  buffer_store_dwordx4 v[202:205], v2, s[84:87], s17 offen offset:0 sc1
  v_cvt_pk_bf16_f32 v206, v154, v155
  v_cvt_pk_bf16_f32 v207, v156, v157
  v_cvt_pk_bf16_f32 v208, v158, v159
  v_cvt_pk_bf16_f32 v209, v160, v161
  buffer_store_dwordx4 v[206:209], v2, s[84:87], s17 offen offset:1024 sc1
  s_waitcnt vmcnt(5)
  v_xor_b32_e64 v126, v3, v126
  v_bitop3_b32 v126, v126, v127, v3 bitop3:0xf6
  v_bitop3_b32 v126, v126, v128, v3 bitop3:0xf6
  v_bitop3_b32 v126, v126, v129, v3 bitop3:0xf6
  v_cmp_ne_u32 vcc, 0, v126
  s_nop 0
  s_cmp_lg_u64 vcc, 0
  s_cbranch_scc1 Lre_13
Lok_14:
  s_movk_i32 s3, 0
  buffer_load_dwordx4 v[210:213], v12, s[84:87], s3 offen sc1
  s_movk_i32 s3, 4096
  buffer_load_dwordx4 v[214:217], v12, s[84:87], s3 offen sc1
  s_movk_i32 s3, 8192
  buffer_load_dwordx4 v[218:221], v12, s[84:87], s3 offen sc1
  s_movk_i32 s3, 12288
  buffer_load_dwordx4 v[222:225], v12, s[84:87], s3 offen sc1
  buffer_load_dwordx4 v[226:229], v15, s[84:87], 0 offen sc1
  ds_write_b128 v19, v[194:197] offset:32768
  ds_write_b128 v19, v[198:201] offset:33792
  v_lshlrev_b32 v10, 2, v1
  s_add_u32 s4, s15, 131072
  s_waitcnt vmcnt(5)
  s_mov_b32 exec_hi, 0
  buffer_store_dword v3, v10, s[84:87], s4 offen sc1
  s_mov_b32 exec_hi, -1
  s_add_u32 m0, s11, 65536
  s_add_u32 s23, s12, 0
  buffer_load_dwordx4 v20, s[48:51], s23 offen lds
  s_add_u32 m0, s11, 66560
  s_add_u32 s23, s12, 49152
  buffer_load_dwordx4 v20, s[48:51], s23 offen lds
  s_add_u32 m0, s11, 67584
  s_add_u32 s23, s12, 98304
  buffer_load_dwordx4 v20, s[48:51], s23 offen lds
  s_add_u32 m0, s11, 68608
  s_add_u32 s23, s12, 147456
  buffer_load_dwordx4 v20, s[48:51], s23 offen lds
  s_add_u32 m0, s11, 69632
  s_add_u32 s23, s12, 196608
  buffer_load_dwordx4 v20, s[48:51], s23 offen lds
  s_add_u32 m0, s11, 70656
  s_add_u32 s23, s12, 245760
  buffer_load_dwordx4 v20, s[48:51], s23 offen lds
  s_add_u32 m0, s11, 71680
  s_add_u32 s23, s12, 294912
  buffer_load_dwordx4 v20, s[48:51], s23 offen lds
  s_add_u32 m0, s11, 72704
  s_add_u32 s23, s12, 344064
  buffer_load_dwordx4 v20, s[48:51], s23 offen lds
  s_waitcnt vmcnt(13)
  v_add_f32 v210, v210, v211
  v_add_f32 v212, v212, v213
  s_waitcnt vmcnt(12)
  v_add_f32 v214, v214, v215
  v_add_f32 v216, v216, v217
  s_waitcnt vmcnt(11)
  v_add_f32 v218, v218, v219
  v_add_f32 v220, v220, v221
  s_waitcnt vmcnt(10)
  v_add_f32 v222, v222, v223
  v_add_f32 v224, v224, v225
  s_waitcnt vmcnt(9)
  v_add_f32 v226, v226, v227
  v_add_f32 v228, v228, v229
  v_add_f32 v210, v210, v212
  v_add_f32 v214, v214, v216
  v_add_f32 v218, v218, v220
  v_add_f32 v222, v222, v224
  v_add_f32_e64 v226, v226, v228
  v_cvt_pk_bf16_f32 v218, 0, v218
  v_cvt_pk_bf16_f32 v222, 0, v222
  v_cvt_pk_bf16_f32 v226, 0, v226
  s_cmp_eq_u32 s92, 2
  s_cselect_b32 s98, 1.0, 0
  v_add_f32 v218, 1.0, v218
  v_add_f32 v222, 1.0, v222
  v_add_f32_e64 v226, s98, v226
  v_cvt_pk_bf16_f32 v218, v218, v222
  v_cvt_pk_bf16_f32 v210, v210, v214
  v_cvt_pk_bf16_f32 v226, 0, v226
  v_mov_b32 v214, 0x3f803f80
  v_lshlrev_b32 v8, 1, v0
  v_add_u32 v8, 156672, v8
  ds_write_b32 v73, v226
  ds_write_b32 v73, v214 offset:3072
  ds_write_b16 v8, v218
  ds_write_b16_d16_hi v8, v218 offset:512
  ds_write_b16 v8, v210 offset:1024
  ds_write_b16_d16_hi v8, v210 offset:1536
  s_waitcnt vmcnt(0)
  s_waitcnt lgkmcnt(0)
  s_barrier
  ds_read_b64_tr_b16 v[178:179], v17 offset:0
  ds_read_b64_tr_b16 v[180:181], v17 offset:256
  ds_read_b64_tr_b16 v[182:183], v17 offset:1024
  ds_read_b64_tr_b16 v[184:185], v17 offset:1280
  ds_read_b64_tr_b16 v[186:187], v17 offset:2048
  ds_read_b64_tr_b16 v[188:189], v17 offset:2304
  s_lshl_b32 s12, s92, 12
  s_add_u32 s12, s12, 0x1a000
  s_mov_b32 s78, s12
  s_mul_i32 s4, s72, 0xfffff800
  s_add_u32 s78, s78, s4
  s_add_u32 s78, s78, 0x8800
  s_mov_b32 s5, 131072
  s_waitcnt lgkmcnt(4)
  v_mfma_f32_32x32x16_bf16 v[162:177], v[178:181], a[0:3], 0
  ds_read_b64_tr_b16 v[190:191], v17 offset:3072
  ds_read_b64_tr_b16 v[192:193], v17 offset:3328
  ds_read_b64_tr_b16 v[118:119], v55 offset:0
  s_waitcnt lgkmcnt(5)
  v_mfma_f32_32x32x16_bf16 v[162:177], v[182:185], a[4:7], v[162:177]
  ds_read_b64_tr_b16 v[178:179], v17 offset:4096
  ds_read_b64_tr_b16 v[180:181], v17 offset:4352
  ds_read_b64_tr_b16 v[120:121], v55 offset:512
  s_waitcnt lgkmcnt(6)
  v_mfma_f32_32x32x16_bf16 v[162:177], v[186:189], a[8:11], v[162:177]
  ds_read_b64_tr_b16 v[182:183], v17 offset:5120
  ds_read_b64_tr_b16 v[184:185], v17 offset:5376
  ds_read_b64_tr_b16 v[122:123], v55 offset:64
  s_waitcnt lgkmcnt(7)
  v_mfma_f32_32x32x16_bf16 v[162:177], v[190:193], a[12:15], v[162:177]
  ds_read_b64_tr_b16 v[186:187], v17 offset:6144
  ds_read_b64_tr_b16 v[188:189], v17 offset:6400
  ds_read_b64_tr_b16 v[124:125], v55 offset:576
  s_waitcnt lgkmcnt(7)
  v_mfma_f32_32x32x16_bf16 v[162:177], v[178:181], a[16:19], v[162:177]
  ds_read_b64_tr_b16 v[190:191], v17 offset:7168
  ds_read_b64_tr_b16 v[192:193], v17 offset:7424
  buffer_load_dword v12, v21, s[84:87], s5 offen sc1
  s_waitcnt lgkmcnt(6)
  v_mfma_f32_32x32x16_bf16 v[162:177], v[182:185], a[20:23], v[162:177]
  ds_read_b64_tr_b16 v[178:179], v17 offset:8192
  ds_read_b64_tr_b16 v[180:181], v17 offset:8448
  s_waitcnt lgkmcnt(5)
  v_mfma_f32_32x32x16_bf16 v[162:177], v[186:189], a[24:27], v[162:177]
  ds_read_b64_tr_b16 v[182:183], v17 offset:9216
  ds_read_b64_tr_b16 v[184:185], v17 offset:9472
  s_waitcnt lgkmcnt(4)
  v_mfma_f32_32x32x16_bf16 v[162:177], v[190:193], a[28:31], v[162:177]
  ds_read_b64_tr_b16 v[186:187], v17 offset:10240
  ds_read_b64_tr_b16 v[188:189], v17 offset:10496
  s_waitcnt lgkmcnt(4)
  v_mfma_f32_32x32x16_bf16 v[162:177], v[178:181], a[32:35], v[162:177]
  ds_read_b64_tr_b16 v[190:191], v17 offset:11264
  ds_read_b64_tr_b16 v[192:193], v17 offset:11520
  s_waitcnt lgkmcnt(4)
  v_mfma_f32_32x32x16_bf16 v[162:177], v[182:185], a[36:39], v[162:177]
  ds_read_b64_tr_b16 v[178:179], v17 offset:12288
  ds_read_b64_tr_b16 v[180:181], v17 offset:12544
  s_waitcnt lgkmcnt(4)
  v_mfma_f32_32x32x16_bf16 v[162:177], v[186:189], a[40:43], v[162:177]
  ds_read_b64_tr_b16 v[182:183], v17 offset:13312
  ds_read_b64_tr_b16 v[184:185], v17 offset:13568
  s_waitcnt lgkmcnt(4)
  v_mfma_f32_32x32x16_bf16 v[162:177], v[190:193], a[44:47], v[162:177]
  ds_read_b64_tr_b16 v[186:187], v17 offset:14336
  ds_read_b64_tr_b16 v[188:189], v17 offset:14592
  s_waitcnt lgkmcnt(4)
  v_mfma_f32_32x32x16_bf16 v[162:177], v[178:181], a[48:51], v[162:177]
  ds_read_b64_tr_b16 v[190:191], v17 offset:15360
  ds_read_b64_tr_b16 v[192:193], v17 offset:15616
  s_waitcnt lgkmcnt(4)
  v_mfma_f32_32x32x16_bf16 v[162:177], v[182:185], a[52:55], v[162:177]
  ds_read_b64_tr_b16 v[178:179], v17 offset:16384
  ds_read_b64_tr_b16 v[180:181], v17 offset:16640
  s_waitcnt lgkmcnt(4)
  v_mfma_f32_32x32x16_bf16 v[162:177], v[186:189], a[56:59], v[162:177]
  ds_read_b64_tr_b16 v[182:183], v17 offset:17408
  ds_read_b64_tr_b16 v[184:185], v17 offset:17664
  s_waitcnt lgkmcnt(4)
  v_mfma_f32_32x32x16_bf16 v[162:177], v[190:193], a[60:63], v[162:177]
  ds_read_b64_tr_b16 v[186:187], v17 offset:18432
  ds_read_b64_tr_b16 v[188:189], v17 offset:18688
  s_waitcnt lgkmcnt(4)
  v_mfma_f32_32x32x16_bf16 v[162:177], v[178:181], a[64:67], v[162:177]
  ds_read_b64_tr_b16 v[190:191], v17 offset:19456
  ds_read_b64_tr_b16 v[192:193], v17 offset:19712
  s_waitcnt lgkmcnt(4)
  v_mfma_f32_32x32x16_bf16 v[162:177], v[182:185], a[68:71], v[162:177]
  ds_read_b64_tr_b16 v[178:179], v17 offset:20480
  ds_read_b64_tr_b16 v[180:181], v17 offset:20736
  s_waitcnt lgkmcnt(4)
  v_mfma_f32_32x32x16_bf16 v[162:177], v[186:189], a[72:75], v[162:177]
  ds_read_b64_tr_b16 v[182:183], v17 offset:21504
  ds_read_b64_tr_b16 v[184:185], v17 offset:21760
  s_waitcnt vmcnt(0)
  v_cmp_ne_u32 vcc, s95, v12
  s_nop 0
  s_cmp_lg_u64 vcc, 0
  s_cbranch_scc1 Lre_16
Lok_17:
  s_mov_b32 m0, s78
  s_nop 0
  buffer_load_dwordx4 v2, s[84:87], s18 offen offset:0 sc1 lds
  buffer_load_dwordx4 v2, s[84:87], s18 offen offset:1024 sc1 lds
  s_add_u32 m0, s12, 16384
  s_nop 0
  buffer_load_dwordx4 v2, s[84:87], s19 offen offset:0 sc1 lds
  buffer_load_dwordx4 v2, s[84:87], s19 offen offset:1024 sc1 lds
  s_mov_b32 m0, s12
  s_nop 0
  buffer_load_dwordx4 v2, s[84:87], s20 offen offset:0 sc1 lds
  buffer_load_dwordx4 v2, s[84:87], s20 offen offset:1024 sc1 lds
  s_waitcnt lgkmcnt(4)
  v_mfma_f32_32x32x16_bf16 v[162:177], v[190:193], a[76:79], v[162:177]
  ds_read_b64_tr_b16 v[186:187], v17 offset:22528
  ds_read_b64_tr_b16 v[188:189], v17 offset:22784
  s_add_u32 m0, s12, 16384
  s_nop 0
  buffer_load_dwordx4 v2, s[84:87], s19 offen offset:2048 sc1 lds
  buffer_load_dwordx4 v2, s[84:87], s19 offen offset:3072 sc1 lds
  s_waitcnt lgkmcnt(4)
  v_mfma_f32_32x32x16_bf16 v[162:177], v[178:181], a[80:83], v[162:177]
  ds_read_b64_tr_b16 v[190:191], v17 offset:23552
  ds_read_b64_tr_b16 v[192:193], v17 offset:23808
  s_mov_b32 m0, s12
  s_nop 0
  buffer_load_dwordx4 v2, s[84:87], s20 offen offset:2048 sc1 lds
  buffer_load_dwordx4 v2, s[84:87], s20 offen offset:3072 sc1 lds
  s_waitcnt lgkmcnt(4)
  v_mfma_f32_32x32x16_bf16 v[162:177], v[182:185], a[84:87], v[162:177]
  ds_read_b64_tr_b16 v[178:179], v17 offset:24576
  ds_read_b64_tr_b16 v[180:181], v17 offset:24832
  s_add_u32 s99, s25, 114688
  s_mov_b64 exec, s[28:29]
  buffer_store_dwordx4 v[118:121], v2, s[84:87], s25 offen sc1
  buffer_store_dwordx4 v[122:125], v2, s[84:87], s99 offen sc1
  s_mov_b64 exec, -1
  s_waitcnt lgkmcnt(4)
  v_mfma_f32_32x32x16_bf16 v[162:177], v[186:189], a[88:91], v[162:177]
  ds_read_b64_tr_b16 v[182:183], v17 offset:25600
  ds_read_b64_tr_b16 v[184:185], v17 offset:25856
  s_waitcnt lgkmcnt(4)
  v_mfma_f32_32x32x16_bf16 v[162:177], v[190:193], a[92:95], v[162:177]
  ds_read_b64_tr_b16 v[186:187], v17 offset:26624
  ds_read_b64_tr_b16 v[188:189], v17 offset:26880
  s_waitcnt lgkmcnt(4)
  v_mfma_f32_32x32x16_bf16 v[162:177], v[178:181], a[96:99], v[162:177]
  ds_read_b64_tr_b16 v[190:191], v17 offset:27648
  ds_read_b64_tr_b16 v[192:193], v17 offset:27904
  s_waitcnt lgkmcnt(4)
  v_mfma_f32_32x32x16_bf16 v[162:177], v[182:185], a[100:103], v[162:177]
  ds_read_b64_tr_b16 v[178:179], v17 offset:28672
  ds_read_b64_tr_b16 v[180:181], v17 offset:28928
  s_waitcnt lgkmcnt(4)
  v_mfma_f32_32x32x16_bf16 v[162:177], v[186:189], a[104:107], v[162:177]
  ds_read_b64_tr_b16 v[182:183], v17 offset:29696
  ds_read_b64_tr_b16 v[184:185], v17 offset:29952
  s_waitcnt lgkmcnt(4)
  v_mfma_f32_32x32x16_bf16 v[162:177], v[190:193], a[108:111], v[162:177]
  ds_read_b64_tr_b16 v[186:187], v17 offset:30720
  ds_read_b64_tr_b16 v[188:189], v17 offset:30976
  s_waitcnt lgkmcnt(4)
  v_mfma_f32_32x32x16_bf16 v[162:177], v[178:181], a[112:115], v[162:177]
  ds_read_b64_tr_b16 v[190:191], v17 offset:31744
  ds_read_b64_tr_b16 v[192:193], v17 offset:32000
  s_waitcnt lgkmcnt(4)
  v_mfma_f32_32x32x16_bf16 v[162:177], v[182:185], a[116:119], v[162:177]
  s_waitcnt lgkmcnt(2)
  v_mfma_f32_32x32x16_bf16 v[162:177], v[186:189], a[120:123], v[162:177]
  s_waitcnt lgkmcnt(0)
  v_mfma_f32_32x32x16_bf16 v[162:177], v[190:193], a[124:127], v[162:177]
  s_mov_b32 s3, 0x3eb8aa3b
  ds_read_b128 v[118:121], v28 offset:0
  ds_read_b128 v[122:125], v28 offset:64
  ds_read_b128 v[126:129], v28 offset:128
  ds_read_b128 v[130:133], v28 offset:192
  ds_read_b128 v[134:137], v28 offset:256
  ds_read_b128 v[138:141], v28 offset:320
  ds_read_b128 v[142:145], v28 offset:384
  ds_read_b128 v[146:149], v28 offset:448
  s_nop 2
  v_mul_f32 v162, s3, v162
  v_mul_f32 v163, s3, v163
  v_mul_f32 v164, s3, v164
  v_mul_f32 v165, s3, v165
  v_mul_f32 v166, s3, v166
  v_mul_f32 v167, s3, v167
  v_mul_f32 v168, s3, v168
  v_mul_f32_e64 v169, s3, v169
  v_cvt_pk_bf16_f32 v34, v162, v163
  v_cvt_pk_bf16_f32 v35, v164, v165
  v_cvt_pk_bf16_f32 v36, v166, v167
  v_cvt_pk_bf16_f32 v37, v168, v169
  s_waitcnt lgkmcnt(7)
  v_mfma_f32_16x16x32_bf16 v[30:33], v[118:121], v[118:121], 0
  s_waitcnt lgkmcnt(6)
  v_mfma_f32_16x16x32_bf16 v[30:33], v[122:125], v[122:125], v[30:33]
  s_waitcnt lgkmcnt(5)
  v_mfma_f32_16x16x32_bf16 v[30:33], v[126:129], v[126:129], v[30:33]
  s_waitcnt lgkmcnt(4)
  v_mfma_f32_16x16x32_bf16 v[30:33], v[130:133], v[130:133], v[30:33]
  s_waitcnt lgkmcnt(3)
  v_mfma_f32_16x16x32_bf16 v[30:33], v[134:137], v[134:137], v[30:33]
  s_waitcnt lgkmcnt(2)
  v_mfma_f32_16x16x32_bf16 v[30:33], v[138:141], v[138:141], v[30:33]
  s_waitcnt lgkmcnt(1)
  v_mfma_f32_16x16x32_bf16 v[30:33], v[142:145], v[142:145], v[30:33]
  s_waitcnt lgkmcnt(0)
  v_mfma_f32_16x16x32_bf16 v[30:33], v[146:149], v[146:149], v[30:33]
  ds_read_b128 v[118:121], v28 offset:512
  ds_read_b128 v[122:125], v28 offset:576
  ds_read_b128 v[126:129], v28 offset:640
  ds_read_b128 v[130:133], v28 offset:704
  ds_read_b128 v[134:137], v28 offset:768
  ds_read_b128 v[138:141], v28 offset:832
  ds_read_b128 v[142:145], v28 offset:896
  ds_read_b128 v[146:149], v28 offset:960
  v_mul_f32 v170, s3, v170
  v_mul_f32 v171, s3, v171
  v_mul_f32 v172, s3, v172
  v_mul_f32 v173, s3, v173
  v_mul_f32 v174, s3, v174
  v_mul_f32 v175, s3, v175
  v_mul_f32 v176, s3, v176
  v_mul_f32 v177, s3, v177
  v_cvt_pk_bf16_f32 v38, v170, v171
  v_cvt_pk_bf16_f32 v39, v172, v173
  v_cvt_pk_bf16_f32 v40, v174, v175
  v_cvt_pk_bf16_f32 v41, v176, v177
  s_waitcnt lgkmcnt(7)
  v_mfma_f32_16x16x32_bf16 v[30:33], v[118:121], v[118:121], v[30:33]
  s_waitcnt lgkmcnt(6)
  v_mfma_f32_16x16x32_bf16 v[30:33], v[122:125], v[122:125], v[30:33]
  s_waitcnt lgkmcnt(5)
  v_mfma_f32_16x16x32_bf16 v[30:33], v[126:129], v[126:129], v[30:33]
  s_waitcnt lgkmcnt(4)
  v_mfma_f32_16x16x32_bf16 v[30:33], v[130:133], v[130:133], v[30:33]
  s_waitcnt lgkmcnt(3)
  v_mfma_f32_16x16x32_bf16 v[30:33], v[134:137], v[134:137], v[30:33]
  s_waitcnt lgkmcnt(2)
  v_mfma_f32_16x16x32_bf16 v[30:33], v[138:141], v[138:141], v[30:33]
  s_waitcnt lgkmcnt(1)
  v_mfma_f32_16x16x32_bf16 v[30:33], v[142:145], v[142:145], v[30:33]
  s_waitcnt lgkmcnt(0)
  v_mfma_f32_16x16x32_bf16 v[30:33], v[146:149], v[146:149], v[30:33]
  s_nop 7
  v_readlane_b32 s48, v30, 0
  v_readlane_b32 s49, v30, 1
  v_readlane_b32 s50, v30, 2
  v_readlane_b32 s51, v31, 1
  v_readlane_b32 s52, v31, 2
  s_waitcnt vmcnt(6)
  s_waitcnt lgkmcnt(0)
  s_barrier
  s_add_u32 m0, s24, 98304
  s_add_u32 s99, s22, 15360
  buffer_load_dwordx4 v52, s[44:47], s22 offen lds
  buffer_load_dwordx4 v52, s[44:47], s99 offen offset:1024 lds
  v_add_u32 v56, 27648, v77
  v_add_u32 v13, 25728, v77
  v_add_u32 v77, 2048, v77
  v_add_u32 v56, 2048, v56
  v_add_u32 v13, 2048, v13
  v_subrev_u32 v12, 1920, v77
  s_lshr_b32 m0, s11, 1
  s_sub_u32 s56, s56, 2048
  s_subb_u32 s57, s57, 0
  s_add_u32 s58, s58, 2048
  s_cmp_ge_u32 s94, 14
  s_cselect_b32 s58, 0, s58
  s_lshr_b32 s98, s90, 15
  s_mul_i32 s12, s98, 0x1c000
  s_lshl_b32 s4, s27, 13
  s_add_u32 s12, s12, s4
  s_add_u32 s12, s12, 0xb00000
  ds_read_b128 a[0:3], v18 offset:32768
  ds_read_b128 a[4:7], v18 offset:33792
  ds_read_b128 a[8:11], v18 offset:28672
  ds_read_b128 a[12:15], v18 offset:29696
  ds_read_b128 a[16:19], v18 offset:24576
  ds_read_b128 a[20:23], v18 offset:25600
  ds_read_b128 a[24:27], v18 offset:20480
  ds_read_b128 a[28:31], v18 offset:21504
  v_mov_b32 v28, 0xff61b1e6
  v_mov_b32 v29, 0xff61b1e6
  v_mov_b32 v30, 0xff61b1e6
  v_mov_b32 v31, 0xff61b1e6
  s_waitcnt lgkmcnt(7)
  v_mfma_f32_32x32x16_bf16 v[150:165], a[0:3], v[34:37], v[78:93]
  s_mov_b64 exec, 520159231
  buffer_load_dword v5, v75, s[84:87], 0 offen
  s_mov_b64 exec, -1
  s_waitcnt lgkmcnt(6)
  v_mfma_f32_32x32x16_bf16 v[166:181], a[4:7], v[38:41], v[78:93]
  buffer_load_dwordx4 v77, s[56:59], s37 offen offset:0 lds
  ds_read_b128 a[72:75], v23 offset:34816
  ds_read_b128 a[76:79], v23 offset:35840
  s_waitcnt lgkmcnt(7)
  v_mfma_f32_32x32x16_bf16 v[118:133], a[8:11], v[34:37], 0
  ds_read_b128 a[32:35], v18 offset:16384
  s_waitcnt lgkmcnt(7)
  v_mfma_f32_32x32x16_bf16 v[134:149], a[12:15], v[38:41], 0
  ds_read_b128 a[36:39], v18 offset:17408
  s_cmp_le_u32 s30, 0
  s_cbranch_scc1 Lx_20
  s_waitcnt lgkmcnt(7)
  v_mfma_f32_32x32x16_bf16 v[182:197], a[16:19], v[34:37], 0
  ds_read_b128 a[40:43], v18 offset:12288
  buffer_load_dwordx4 a[128:131], v2, s[84:87], s31 offen offset:0 sc1
  s_nop 1
  v_max3_f32 v28, v118, v119, v28
  v_max3_f32 v29, v120, v121, v29
  v_max3_f32 v28, v122, v123, v28
  v_max3_f32 v29, v124, v125, v29
  v_max3_f32 v28, v126, v127, v28
  v_max3_f32 v29, v128, v129, v29
  v_max3_f32 v28, v130, v131, v28
  v_max3_f32 v29, v132, v133, v29
  s_waitcnt lgkmcnt(7)
  v_mfma_f32_32x32x16_bf16 v[198:213], a[20:23], v[38:41], 0
  ds_read_b128 a[44:47], v18 offset:13312
  s_nop 0
  v_max3_f32 v30, v134, v135, v30
  v_max3_f32 v31, v136, v137, v31
  v_max3_f32 v30, v138, v139, v30
  v_max3_f32 v31, v140, v141, v31
  v_max3_f32 v30, v142, v143, v30
  v_max3_f32 v31, v144, v145, v31
  v_max3_f32 v30, v146, v147, v30
  v_max3_f32 v31, v148, v149, v31
  s_cmp_le_u32 s30, 1
  s_cbranch_scc1 Lx_21
  s_waitcnt lgkmcnt(7)
  v_mfma_f32_32x32x16_bf16 v[118:133], a[24:27], v[34:37], 0
  ds_read_b128 a[48:51], v18 offset:8192
  buffer_load_dwordx4 v56, s[56:59], s37 offen offset:1024 lds
  s_nop 0
  v_max3_f32 v28, v182, v183, v28
  v_max3_f32 v29, v184, v185, v29
  v_max3_f32 v28, v186, v187, v28
  v_max3_f32 v29, v188, v189, v29
  v_max3_f32 v28, v190, v191, v28
  v_max3_f32 v29, v192, v193, v29
  v_max3_f32 v28, v194, v195, v28
  v_max3_f32 v29, v196, v197, v29
  s_waitcnt lgkmcnt(7)
  v_mfma_f32_32x32x16_bf16 v[134:149], a[28:31], v[38:41], 0
  ds_read_b128 a[52:55], v18 offset:9216
  s_nop 0
  v_max3_f32 v30, v198, v199, v30
  v_max3_f32 v31, v200, v201, v31
  v_max3_f32 v30, v202, v203, v30
  v_max3_f32 v31, v204, v205, v31
  v_max3_f32 v30, v206, v207, v30
  v_max3_f32 v31, v208, v209, v31
  v_max3_f32 v30, v210, v211, v30
  v_max3_f32 v31, v212, v213, v31
  s_cmp_le_u32 s30, 2
  s_cbranch_scc1 Lx_22
  s_waitcnt lgkmcnt(5)
  v_mfma_f32_32x32x16_bf16 v[182:197], a[32:35], v[34:37], 0
  ds_read_b128 a[56:59], v18 offset:4096
  buffer_load_dwordx4 v12, s[56:59], s37 offen offset:2048 lds
  s_nop 0
  v_max3_f32 v28, v118, v119, v28
  v_max3_f32 v29, v120, v121, v29
  v_max3_f32 v28, v122, v123, v28
  v_max3_f32 v29, v124, v125, v29
  v_max3_f32 v28, v126, v127, v28
  v_max3_f32 v29, v128, v129, v29
  v_max3_f32 v28, v130, v131, v28
  v_max3_f32 v29, v132, v133, v29
  s_waitcnt lgkmcnt(5)
  v_mfma_f32_32x32x16_bf16 v[198:213], a[36:39], v[38:41], 0
  ds_read_b128 a[60:63], v18 offset:5120
  s_nop 0
  v_max3_f32 v30, v134, v135, v30
  v_max3_f32 v31, v136, v137, v31
  v_max3_f32 v30, v138, v139, v30
  v_max3_f32 v31, v140, v141, v31
  v_max3_f32 v30, v142, v143, v30
  v_max3_f32 v31, v144, v145, v31
  v_max3_f32 v30, v146, v147, v30
  v_max3_f32 v31, v148, v149, v31
  s_cmp_le_u32 s30, 3
  s_cbranch_scc1 Lx_23
  s_waitcnt lgkmcnt(5)
  v_mfma_f32_32x32x16_bf16 v[118:133], a[40:43], v[34:37], 0
  ds_read_b128 a[64:67], v18 offset:0
  buffer_load_dwordx4 a[192:195], v2, s[84:87], s32 offen offset:0 sc1
  s_nop 0
  v_max3_f32 v28, v182, v183, v28
  v_max3_f32 v29, v184, v185, v29
  v_max3_f32 v28, v186, v187, v28
  v_max3_f32 v29, v188, v189, v29
  v_max3_f32 v28, v190, v191, v28
  v_max3_f32 v29, v192, v193, v29
  v_max3_f32 v28, v194, v195, v28
  v_max3_f32 v29, v196, v197, v29
  s_waitcnt lgkmcnt(5)
  v_mfma_f32_32x32x16_bf16 v[134:149], a[44:47], v[38:41], 0
  ds_read_b128 a[68:71], v18 offset:1024
  s_nop 0
  v_max3_f32 v30, v198, v199, v30
  v_max3_f32 v31, v200, v201, v31
  v_max3_f32 v30, v202, v203, v30
  v_max3_f32 v31, v204, v205, v31
  v_max3_f32 v30, v206, v207, v30
  v_max3_f32 v31, v208, v209, v31
  v_max3_f32 v30, v210, v211, v30
  v_max3_f32 v31, v212, v213, v31
  s_cmp_le_u32 s30, 4
  s_cbranch_scc1 Lx_24
  s_waitcnt lgkmcnt(5)
  v_mfma_f32_32x32x16_bf16 v[182:197], a[48:51], v[34:37], 0
  buffer_load_dwordx4 v13, s[56:59], s37 offen offset:3072 lds
  s_add_u32 m0, m0, 16384
  s_add_u32 s37, s37, 229376
  s_nop 0
  v_max3_f32 v28, v118, v119, v28
  v_max3_f32 v29, v120, v121, v29
  v_max3_f32 v28, v122, v123, v28
  v_max3_f32 v29, v124, v125, v29
  v_max3_f32 v28, v126, v127, v28
  v_max3_f32 v29, v128, v129, v29
  v_max3_f32 v28, v130, v131, v28
  v_max3_f32 v29, v132, v133, v29
  s_waitcnt lgkmcnt(4)
  v_mfma_f32_32x32x16_bf16 v[198:213], a[52:55], v[38:41], 0
  s_nop 0
  v_max3_f32 v30, v134, v135, v30
  v_max3_f32 v31, v136, v137, v31
  v_max3_f32 v30, v138, v139, v30
  v_max3_f32 v31, v140, v141, v31
  v_max3_f32 v30, v142, v143, v30
  v_max3_f32 v31, v144, v145, v31
  v_max3_f32 v30, v146, v147, v30
  v_max3_f32 v31, v148, v149, v31
  s_cmp_le_u32 s30, 5
  s_cbranch_scc1 Lx_25
  s_waitcnt lgkmcnt(3)
  v_mfma_f32_32x32x16_bf16 v[118:133], a[56:59], v[34:37], 0
  buffer_load_dwordx4 v77, s[56:59], s37 offen offset:0 lds
  s_nop 0
  v_max3_f32 v28, v182, v183, v28
  v_max3_f32 v29, v184, v185, v29
  v_max3_f32 v28, v186, v187, v28
  v_max3_f32 v29, v188, v189, v29
  v_max3_f32 v28, v190, v191, v28
  v_max3_f32 v29, v192, v193, v29
  v_max3_f32 v28, v194, v195, v28
  v_max3_f32 v29, v196, v197, v29
  s_waitcnt lgkmcnt(2)
  v_mfma_f32_32x32x16_bf16 v[134:149], a[60:63], v[38:41], 0
  s_nop 0
  v_max3_f32 v30, v198, v199, v30
  v_max3_f32 v31, v200, v201, v31
  v_max3_f32 v30, v202, v203, v30
  v_max3_f32 v31, v204, v205, v31
  v_max3_f32 v30, v206, v207, v30
  v_max3_f32 v31, v208, v209, v31
  v_max3_f32 v30, v210, v211, v30
  v_max3_f32 v31, v212, v213, v31
  s_cmp_le_u32 s30, 6
  s_cbranch_scc1 Lx_26
  s_waitcnt lgkmcnt(1)
  v_mfma_f32_32x32x16_bf16 v[182:197], a[64:67], v[34:37], v[94:109]
  buffer_load_dwordx4 a[132:135], v2, s[84:87], s31 offen offset:1024 sc1
  s_nop 0
  v_max3_f32 v28, v118, v119, v28
  v_max3_f32 v29, v120, v121, v29
  v_max3_f32 v28, v122, v123, v28
  v_max3_f32 v29, v124, v125, v29
  v_max3_f32 v28, v126, v127, v28
  v_max3_f32 v29, v128, v129, v29
  v_max3_f32 v28, v130, v131, v28
  v_max3_f32 v29, v132, v133, v29
  s_waitcnt lgkmcnt(0)
  v_mfma_f32_32x32x16_bf16 v[198:213], a[68:71], v[38:41], v[94:109]
  s_nop 0
  v_max3_f32 v30, v134, v135, v30
  v_max3_f32 v31, v136, v137, v31
  v_max3_f32 v30, v138, v139, v30
  v_max3_f32 v31, v140, v141, v31
  v_max3_f32 v30, v142, v143, v30
  v_max3_f32 v31, v144, v145, v31
  v_max3_f32 v30, v146, v147, v30
  v_max3_f32 v31, v148, v149, v31
  s_cmp_le_u32 s30, 7
  s_cbranch_scc1 Lx_27
  buffer_load_dwordx4 v56, s[56:59], s37 offen offset:1024 lds
  v_max_f32 v150, v150, v182
  v_max_f32 v151, v151, v183
  v_max_f32 v152, v152, v184
  v_max_f32 v153, v153, v185
  v_max_f32 v154, v154, v186
  v_max_f32 v155, v155, v187
  v_max_f32 v156, v156, v188
  v_max_f32 v157, v157, v189
  v_max_f32 v158, v158, v190
  v_max_f32 v159, v159, v191
  v_max_f32 v160, v160, v192
  v_max_f32 v161, v161, v193
  v_max_f32 v162, v162, v194
  v_max_f32 v163, v163, v195
  v_max_f32 v164, v164, v196
  v_max_f32 v165, v165, v197
  v_max_f32 v166, v166, v198
  v_max_f32 v167, v167, v199
  v_max_f32 v168, v168, v200
  v_max_f32 v169, v169, v201
  v_max_f32 v170, v170, v202
  v_max_f32 v171, v171, v203
  v_max_f32 v172, v172, v204
  v_max_f32 v173, v173, v205
  v_max_f32 v174, v174, v206
  v_max_f32 v175, v175, v207
  v_max_f32 v176, v176, v208
  v_max_f32 v177, v177, v209
  v_max_f32 v178, v178, v210
  v_max_f32 v179, v179, v211
  v_max_f32 v180, v180, v212
  v_max_f32_e64 v181, v181, v213
Lp1_19:
  s_waitcnt lgkmcnt(0)
  buffer_load_dwordx4 v12, s[56:59], s37 offen offset:2048 lds
  buffer_load_dwordx4 a[196:199], v2, s[84:87], s32 offen offset:1024 sc1
  v_max3_f32 v28, v150, v151, v28
  v_max3_f32 v29, v152, v153, v29
  v_max3_f32 v28, v154, v155, v28
  v_max3_f32 v29, v156, v157, v29
  v_max3_f32 v28, v158, v159, v28
  v_max3_f32 v29, v160, v161, v29
  v_max3_f32 v28, v162, v163, v28
  v_max3_f32 v29, v164, v165, v29
  v_max3_f32 v30, v166, v167, v30
  v_max3_f32 v31, v168, v169, v31
  v_max3_f32 v30, v170, v171, v30
  v_max3_f32 v31, v172, v173, v31
  v_max3_f32 v30, v174, v175, v30
  v_max3_f32 v31, v176, v177, v31
  v_max3_f32 v30, v178, v179, v30
  v_max3_f32 v31, v180, v181, v31
  v_max_f32 v28, v28, v29
  v_max_f32 v30, v30, v31
  v_mov_b32 v32, v28
  v_mov_b32 v33, v30
  s_nop 0
  v_permlane32_swap_b32 v28, v32
  v_permlane32_swap_b32 v30, v33
  v_max_f32 v28, v28, v32
  v_max_f32 v30, v30, v33
  v_sub_f32 v182, 0, v28
  v_sub_f32 v198, 0, v30
  v_sub_f32 v183, 0, v28
  v_sub_f32_e64 v199, 0, v30
  v_pk_add_f32 v[150:151], v[150:151], v[182:183]
  v_pk_add_f32 v[152:153], v[152:153], v[182:183]
  v_pk_add_f32 v[154:155], v[154:155], v[182:183]
  v_pk_add_f32 v[156:157], v[156:157], v[182:183]
  v_pk_add_f32 v[158:159], v[158:159], v[182:183]
  v_pk_add_f32 v[160:161], v[160:161], v[182:183]
  v_pk_add_f32 v[162:163], v[162:163], v[182:183]
  v_pk_add_f32 v[164:165], v[164:165], v[182:183]
  v_pk_add_f32 v[166:167], v[166:167], v[198:199]
  v_pk_add_f32 v[168:169], v[168:169], v[198:199]
  v_pk_add_f32 v[170:171], v[170:171], v[198:199]
  v_pk_add_f32 v[172:173], v[172:173], v[198:199]
  v_pk_add_f32 v[174:175], v[174:175], v[198:199]
  v_pk_add_f32 v[176:177], v[176:177], v[198:199]
  v_pk_add_f32 v[178:179], v[178:179], v[198:199]
  v_pk_add_f32 v[180:181], v[180:181], v[198:199]
  v_pk_mov_b32 v[184:185], v[182:183], v[182:183] op_sel:[0,1]
  v_pk_mov_b32 v[186:187], v[182:183], v[182:183] op_sel:[0,1]
  v_pk_mov_b32 v[188:189], v[182:183], v[182:183] op_sel:[0,1]
  v_pk_mov_b32 v[190:191], v[182:183], v[182:183] op_sel:[0,1]
  v_pk_mov_b32 v[192:193], v[182:183], v[182:183] op_sel:[0,1]
  v_pk_mov_b32 v[194:195], v[182:183], v[182:183] op_sel:[0,1]
  v_pk_mov_b32 v[196:197], v[182:183], v[182:183] op_sel:[0,1]
  v_pk_mov_b32 v[200:201], v[198:199], v[198:199] op_sel:[0,1]
  v_pk_mov_b32 v[202:203], v[198:199], v[198:199] op_sel:[0,1]
  v_pk_mov_b32 v[204:205], v[198:199], v[198:199] op_sel:[0,1]
  v_pk_mov_b32 v[206:207], v[198:199], v[198:199] op_sel:[0,1]
  v_pk_mov_b32 v[208:209], v[198:199], v[198:199] op_sel:[0,1]
  v_pk_mov_b32 v[210:211], v[198:199], v[198:199] op_sel:[0,1]
  v_pk_mov_b32 v[212:213], v[198:199], v[198:199] op_sel:[0,1]
  s_waitcnt lgkmcnt(0)
  s_waitcnt vmcnt(14)
  s_barrier
  s_add_u32 s4, s13, 0x6000
  s_cmp_eq_u32 s92, 1
  s_cselect_b64 exec, 1, 0
  buffer_store_dword v3, v4, s[84:87], s4 offen sc1
  s_mov_b64 exec, -1
  s_movk_i32 s77, 24576
  ds_read_b128 a[80:83], v23 offset:30720
  ds_read_b128 a[84:87], v23 offset:31744
  v_exp_f32 v150, v150
  v_exp_f32 v151, v151
  v_exp_f32 v152, v152
  v_exp_f32 v153, v153
  v_exp_f32 v154, v154
  v_exp_f32 v155, v155
  v_exp_f32 v156, v156
  v_exp_f32_e64 v157, v157
  buffer_load_dwordx4 v13, s[56:59], s37 offen offset:3072 lds
  s_add_u32 m0, m0, 16384
  s_add_u32 s37, s37, 229376
  v_cvt_pk_bf16_f32 v62, v150, v151
  v_cvt_pk_bf16_f32 v63, v152, v153
  v_cvt_pk_bf16_f32 v64, v154, v155
  v_cvt_pk_bf16_f32 v65, v156, v157
  ds_read_b128 a[88:91], v23 offset:26624
  v_exp_f32 v158, v158
  v_exp_f32 v159, v159
  v_exp_f32 v160, v160
  v_exp_f32 v161, v161
  v_mfma_f32_16x16x32_bf16 v[102:105], v[24:27], v[62:65], 0
  buffer_load_dwordx4 v77, s[56:59], s37 offen offset:0 lds
  v_exp_f32 v162, v162
  v_exp_f32 v163, v163
  v_exp_f32 v164, v164
  v_exp_f32 v165, v165
  v_bfi_b32 v150, v110, v4, v62
  v_and_b32 v62, v110, v62
  v_bfi_b32 v151, v111, v4, v63
  v_and_b32 v63, v111, v63
  v_bfi_b32 v152, v112, v4, v64
  v_and_b32 v64, v112, v64
  v_bfi_b32 v153, v113, v4, v65
  v_and_b32 v65, v113, v65
  v_cvt_pk_bf16_f32 v66, v158, v159
  v_cvt_pk_bf16_f32 v67, v160, v161
  v_cvt_pk_bf16_f32 v68, v162, v163
  v_cvt_pk_bf16_f32 v69, v164, v165
  v_mfma_f32_32x32x16_bf16 v[86:101], a[72:75], v[62:65], 0
  buffer_load_dwordx4 a[136:139], v2, s[84:87], s31 offen offset:2048 sc1
  v_exp_f32 v166, v166
  v_exp_f32 v167, v167
  v_exp_f32 v168, v168
  v_exp_f32 v169, v169
  v_mfma_f32_16x16x32_bf16 v[102:105], v[24:27], v[66:69], v[102:105]
  v_exp_f32 v170, v170
  v_exp_f32 v171, v171
  v_exp_f32 v172, v172
  v_exp_f32 v173, v173
  v_bfi_b32 v154, v114, v4, v66
  v_and_b32 v66, v114, v66
  v_bfi_b32 v155, v115, v4, v67
  v_and_b32 v67, v115, v67
  v_bfi_b32 v156, v116, v4, v68
  v_and_b32 v68, v116, v68
  v_bfi_b32 v157, v117, v4, v69
  v_and_b32 v69, v117, v69
  buffer_load_dwordx4 v56, s[56:59], s37 offen offset:1024 lds
  v_cvt_pk_bf16_f32 v78, v166, v167
  v_cvt_pk_bf16_f32 v79, v168, v169
  v_mfma_f32_32x32x16_bf16 v[86:101], a[76:79], v[66:69], v[86:101]
  v_cvt_pk_bf16_f32 v80, v170, v171
  v_cvt_pk_bf16_f32 v81, v172, v173
  ds_read_b128 a[92:95], v23 offset:27648
  v_exp_f32 v174, v174
  v_exp_f32 v175, v175
  v_exp_f32 v176, v176
  v_exp_f32 v177, v177
  v_mfma_f32_16x16x32_bf16 v[106:109], v[24:27], v[78:81], 0
  buffer_load_dwordx4 v12, s[56:59], s37 offen offset:2048 lds
  v_exp_f32 v178, v178
  v_exp_f32 v179, v179
  v_mfma_f32_32x32x16_bf16 v[118:133], a[8:11], v[34:37], v[182:197]
  v_exp_f32 v180, v180
  v_exp_f32 v181, v181
  v_bfi_b32 v166, v110, v4, v78
  v_and_b32 v78, v110, v78
  v_bfi_b32 v167, v111, v4, v79
  v_and_b32 v79, v111, v79
  v_bfi_b32 v168, v112, v4, v80
  v_and_b32 v80, v112, v80
  v_bfi_b32 v169, v113, v4, v81
  v_and_b32 v81, v113, v81
  v_cvt_pk_bf16_f32 v82, v174, v175
  v_cvt_pk_bf16_f32 v83, v176, v177
  v_cvt_pk_bf16_f32 v84, v178, v179
  v_cvt_pk_bf16_f32 v85, v180, v181
  v_mfma_f32_32x32x16_bf16 v[214:229], a[72:75], v[78:81], 0
  buffer_load_dwordx4 a[200:203], v2, s[84:87], s32 offen offset:2048 sc1
  v_mfma_f32_16x16x32_bf16 v[106:109], v[24:27], v[82:85], v[106:109]
  v_bfi_b32 v170, v114, v4, v82
  v_and_b32 v82, v114, v82
  v_bfi_b32 v171, v115, v4, v83
  v_and_b32 v83, v115, v83
  v_bfi_b32 v172, v116, v4, v84
  v_and_b32 v84, v116, v84
  v_bfi_b32 v173, v117, v4, v85
  v_and_b32 v85, v117, v85
  s_nop 1
  v_mfma_f32_32x32x16_bf16 v[214:229], a[76:79], v[82:85], v[214:229]
Lend_29:
  s_cmp_lt_u32 s30, 1
  s_cbranch_scc1 Lsk_30
  v_exp_f32 v118, v118
  v_exp_f32 v119, v119
  v_exp_f32 v120, v120
  v_exp_f32 v121, v121
  v_mfma_f32_32x32x16_bf16 v[134:149], a[12:15], v[38:41], v[198:213]
  v_exp_f32 v122, v122
  v_exp_f32 v123, v123
  v_exp_f32 v124, v124
  v_exp_f32_e64 v125, v125
  buffer_load_dwordx4 v13, s[56:59], s37 offen offset:3072 lds
  s_add_u32 m0, m0, 16384
  s_add_u32 s37, s37, 229376
  v_cvt_pk_bf16_f32 v62, v118, v119
  v_cvt_pk_bf16_f32 v63, v120, v121
  v_cvt_pk_bf16_f32 v64, v122, v123
  v_cvt_pk_bf16_f32 v65, v124, v125
  ds_read_b128 a[96:99], v23 offset:22528
  v_exp_f32 v126, v126
  v_exp_f32 v127, v127
  v_exp_f32 v128, v128
  v_exp_f32 v129, v129
  s_waitcnt lgkmcnt(4)
  v_mfma_f32_32x32x16_bf16 v[86:101], a[80:83], v[62:65], v[86:101]
  buffer_load_dwordx4 v77, s[56:59], s37 offen offset:0 lds
  v_exp_f32 v130, v130
  v_exp_f32 v131, v131
  v_exp_f32 v132, v132
  v_exp_f32_e64 v133, v133
  v_mfma_f32_16x16x32_bf16 v[102:105], v[24:27], v[62:65], v[102:105]
  v_cvt_pk_bf16_f32 v66, v126, v127
  v_cvt_pk_bf16_f32 v67, v128, v129
  v_cvt_pk_bf16_f32 v68, v130, v131
  v_cvt_pk_bf16_f32 v69, v132, v133
  buffer_load_dwordx4 a[140:143], v2, s[84:87], s31 offen offset:3072 sc1
  s_add_u32 s31, s31, 4096
  v_exp_f32 v134, v134
  v_exp_f32 v135, v135
  v_exp_f32 v136, v136
  v_exp_f32 v137, v137
  s_waitcnt lgkmcnt(3)
  v_mfma_f32_32x32x16_bf16 v[86:101], a[84:87], v[66:69], v[86:101]
  v_exp_f32 v138, v138
  v_exp_f32 v139, v139
  v_exp_f32 v140, v140
  v_exp_f32 v141, v141
  v_mfma_f32_16x16x32_bf16 v[102:105], v[24:27], v[66:69], v[102:105]
  buffer_load_dwordx4 v56, s[56:59], s37 offen offset:1024 lds
  v_cvt_pk_bf16_f32 v78, v134, v135
  v_cvt_pk_bf16_f32 v79, v136, v137
  v_mfma_f32_32x32x16_bf16 v[118:133], a[16:19], v[34:37], v[182:197]
  v_cvt_pk_bf16_f32 v80, v138, v139
  v_cvt_pk_bf16_f32 v81, v140, v141
  ds_read_b128 a[100:103], v23 offset:23552
  v_exp_f32 v142, v142
  v_exp_f32 v143, v143
  v_exp_f32 v144, v144
  v_exp_f32 v145, v145
  v_mfma_f32_32x32x16_bf16 v[214:229], a[80:83], v[78:81], v[214:229]
  buffer_load_dwordx4 v12, s[56:59], s37 offen offset:2048 lds
  v_exp_f32 v146, v146
  v_exp_f32 v147, v147
  v_exp_f32 v148, v148
  v_exp_f32_e64 v149, v149
  v_mfma_f32_16x16x32_bf16 v[106:109], v[24:27], v[78:81], v[106:109]
  v_cvt_pk_bf16_f32 v82, v142, v143
  v_cvt_pk_bf16_f32 v83, v144, v145
  v_cvt_pk_bf16_f32 v84, v146, v147
  v_cvt_pk_bf16_f32 v85, v148, v149
  buffer_load_dwordx4 a[204:207], v2, s[84:87], s32 offen offset:3072 sc1
  s_add_u32 s32, s32, 4096
  v_mfma_f32_16x16x32_bf16 v[106:109], v[24:27], v[82:85], v[106:109]
  v_mfma_f32_32x32x16_bf16 v[214:229], a[84:87], v[82:85], v[214:229]
Lend_31:
  s_cmp_lt_u32 s30, 2
  s_cbranch_scc1 Lsk_32
  v_exp_f32 v118, v118
  v_exp_f32 v119, v119
  v_exp_f32 v120, v120
  v_exp_f32 v121, v121
  v_mfma_f32_32x32x16_bf16 v[134:149], a[20:23], v[38:41], v[198:213]
  v_exp_f32 v122, v122
  v_exp_f32 v123, v123
  v_exp_f32 v124, v124
  v_exp_f32 v125, v125
  buffer_load_dwordx4 v13, s[56:59], s37 offen offset:3072 lds
  s_add_u32 m0, m0, 16384
  s_add_u32 s37, s37, 229376
  v_cvt_pk_bf16_f32 v62, v118, v119
  v_cvt_pk_bf16_f32 v63, v120, v121
  v_cvt_pk_bf16_f32 v64, v122, v123
  v_cvt_pk_bf16_f32 v65, v124, v125
  ds_read_b128 a[72:75], v23 offset:18432
  v_exp_f32 v126, v126
  v_exp_f32 v127, v127
  v_exp_f32 v128, v128
  v_exp_f32 v129, v129
  s_waitcnt lgkmcnt(4)
  v_mfma_f32_32x32x16_bf16 v[86:101], a[88:91], v[62:65], v[86:101]
  buffer_load_dwordx4 v77, s[56:59], s37 offen offset:0 lds
  v_exp_f32 v130, v130
  v_exp_f32 v131, v131
  v_exp_f32 v132, v132
  v_exp_f32_e64 v133, v133
  v_mfma_f32_16x16x32_bf16 v[102:105], v[24:27], v[62:65], v[102:105]
  v_cvt_pk_bf16_f32 v66, v126, v127
  v_cvt_pk_bf16_f32 v67, v128, v129
  v_cvt_pk_bf16_f32 v68, v130, v131
  v_cvt_pk_bf16_f32 v69, v132, v133
  buffer_load_dwordx4 a[144:147], v2, s[84:87], s31 offen offset:0 sc1
  v_exp_f32 v134, v134
  v_exp_f32 v135, v135
  v_exp_f32 v136, v136
  v_exp_f32 v137, v137
  s_waitcnt lgkmcnt(3)
  v_mfma_f32_32x32x16_bf16 v[86:101], a[92:95], v[66:69], v[86:101]
  v_exp_f32 v138, v138
  v_exp_f32 v139, v139
  v_exp_f32 v140, v140
  v_exp_f32 v141, v141
  v_mfma_f32_16x16x32_bf16 v[102:105], v[24:27], v[66:69], v[102:105]
  buffer_load_dwordx4 v56, s[56:59], s37 offen offset:1024 lds
  v_cvt_pk_bf16_f32 v78, v134, v135
  v_cvt_pk_bf16_f32 v79, v136, v137
  v_mfma_f32_32x32x16_bf16 v[118:133], a[24:27], v[34:37], v[182:197]
  v_cvt_pk_bf16_f32 v80, v138, v139
  v_cvt_pk_bf16_f32 v81, v140, v141
  ds_read_b128 a[76:79], v23 offset:19456
  v_exp_f32 v142, v142
  v_exp_f32 v143, v143
  v_exp_f32 v144, v144
  v_exp_f32 v145, v145
  v_mfma_f32_32x32x16_bf16 v[214:229], a[88:91], v[78:81], v[214:229]
  buffer_load_dwordx4 v12, s[56:59], s37 offen offset:2048 lds
  v_exp_f32 v146, v146
  v_exp_f32 v147, v147
  v_exp_f32 v148, v148
  v_exp_f32_e64 v149, v149
  v_mfma_f32_16x16x32_bf16 v[106:109], v[24:27], v[78:81], v[106:109]
  v_cvt_pk_bf16_f32 v82, v142, v143
  v_cvt_pk_bf16_f32 v83, v144, v145
  v_cvt_pk_bf16_f32 v84, v146, v147
  v_cvt_pk_bf16_f32 v85, v148, v149
  buffer_load_dwordx4 a[208:211], v2, s[84:87], s32 offen offset:0 sc1
  s_nop 0
  v_mfma_f32_16x16x32_bf16 v[106:109], v[24:27], v[82:85], v[106:109]
  v_mfma_f32_32x32x16_bf16 v[214:229], a[92:95], v[82:85], v[214:229]
Lend_33:
  s_cmp_lt_u32 s30, 3
  s_cbranch_scc1 Lsk_34
  v_exp_f32 v118, v118
  v_exp_f32 v119, v119
  v_exp_f32 v120, v120
  v_exp_f32 v121, v121
  v_mfma_f32_32x32x16_bf16 v[134:149], a[28:31], v[38:41], v[198:213]
  v_exp_f32 v122, v122
  v_exp_f32 v123, v123
  v_exp_f32 v124, v124
  v_exp_f32_e64 v125, v125
  buffer_load_dwordx4 v13, s[56:59], s37 offen offset:3072 lds
  s_add_u32 m0, m0, 16384
  s_add_u32 s37, s37, 229376
  v_cvt_pk_bf16_f32 v62, v118, v119
  v_cvt_pk_bf16_f32 v63, v120, v121
  v_cvt_pk_bf16_f32 v64, v122, v123
  v_cvt_pk_bf16_f32 v65, v124, v125
  ds_read_b128 a[80:83], v23 offset:14336
  v_exp_f32 v126, v126
  v_exp_f32 v127, v127
  v_exp_f32 v128, v128
  v_exp_f32 v129, v129
  s_waitcnt lgkmcnt(4)
  v_mfma_f32_32x32x16_bf16 v[86:101], a[96:99], v[62:65], v[86:101]
  buffer_load_dwordx4 v77, s[56:59], s37 offen offset:0 lds
  v_exp_f32 v130, v130
  v_exp_f32 v131, v131
  v_exp_f32 v132, v132
  v_exp_f32_e64 v133, v133
  v_mfma_f32_16x16x32_bf16 v[102:105], v[24:27], v[62:65], v[102:105]
  v_cvt_pk_bf16_f32 v66, v126, v127
  v_cvt_pk_bf16_f32 v67, v128, v129
  v_cvt_pk_bf16_f32 v68, v130, v131
  v_cvt_pk_bf16_f32 v69, v132, v133
  buffer_load_dwordx4 a[148:151], v2, s[84:87], s31 offen offset:1024 sc1
  v_exp_f32 v134, v134
  v_exp_f32 v135, v135
  v_exp_f32 v136, v136
  v_exp_f32 v137, v137
  s_waitcnt lgkmcnt(3)
  v_mfma_f32_32x32x16_bf16 v[86:101], a[100:103], v[66:69], v[86:101]
  v_exp_f32 v138, v138
  v_exp_f32 v139, v139
  v_exp_f32 v140, v140
  v_exp_f32 v141, v141
  v_mfma_f32_16x16x32_bf16 v[102:105], v[24:27], v[66:69], v[102:105]
  buffer_load_dwordx4 v56, s[56:59], s37 offen offset:1024 lds
  v_cvt_pk_bf16_f32 v78, v134, v135
  v_cvt_pk_bf16_f32 v79, v136, v137
  v_mfma_f32_32x32x16_bf16 v[118:133], a[32:35], v[34:37], v[182:197]
  v_cvt_pk_bf16_f32 v80, v138, v139
  v_cvt_pk_bf16_f32 v81, v140, v141
  ds_read_b128 a[84:87], v23 offset:15360
  v_exp_f32 v142, v142
  v_exp_f32 v143, v143
  v_exp_f32 v144, v144
  v_exp_f32 v145, v145
  v_mfma_f32_32x32x16_bf16 v[214:229], a[96:99], v[78:81], v[214:229]
  buffer_load_dwordx4 v12, s[56:59], s37 offen offset:2048 lds
  v_exp_f32 v146, v146
  v_exp_f32 v147, v147
  v_exp_f32 v148, v148
  v_exp_f32_e64 v149, v149
  v_mfma_f32_16x16x32_bf16 v[106:109], v[24:27], v[78:81], v[106:109]
  v_cvt_pk_bf16_f32 v82, v142, v143
  v_cvt_pk_bf16_f32 v83, v144, v145
  v_cvt_pk_bf16_f32 v84, v146, v147
  v_cvt_pk_bf16_f32 v85, v148, v149
  buffer_load_dwordx4 a[212:215], v2, s[84:87], s32 offen offset:1024 sc1
  s_nop 0
  v_mfma_f32_16x16x32_bf16 v[106:109], v[24:27], v[82:85], v[106:109]
  v_mfma_f32_32x32x16_bf16 v[214:229], a[100:103], v[82:85], v[214:229]
Lend_35:
  s_cmp_lt_u32 s30, 4
  s_cbranch_scc1 Lsk_36
  v_exp_f32 v118, v118
  v_exp_f32 v119, v119
  v_exp_f32 v120, v120
  v_exp_f32 v121, v121
  v_mfma_f32_32x32x16_bf16 v[134:149], a[36:39], v[38:41], v[198:213]
  v_exp_f32 v122, v122
  v_exp_f32 v123, v123
  v_exp_f32 v124, v124
  v_exp_f32_e64 v125, v125
  buffer_load_dwordx4 v13, s[56:59], s37 offen offset:3072 lds
  s_add_u32 m0, m0, 16384
  s_add_u32 s37, s37, 229376
  v_cvt_pk_bf16_f32 v62, v118, v119
  v_cvt_pk_bf16_f32 v63, v120, v121
  v_cvt_pk_bf16_f32 v64, v122, v123
  v_cvt_pk_bf16_f32 v65, v124, v125
  ds_read_b128 a[88:91], v23 offset:10240
  v_exp_f32 v126, v126
  v_exp_f32 v127, v127
  v_exp_f32 v128, v128
  v_exp_f32 v129, v129
  s_waitcnt lgkmcnt(4)
  v_mfma_f32_32x32x16_bf16 v[86:101], a[72:75], v[62:65], v[86:101]
  buffer_load_dwordx4 a[152:155], v2, s[84:87], s31 offen offset:2048 sc1
  v_exp_f32 v130, v130
  v_exp_f32 v131, v131
  v_exp_f32 v132, v132
  v_exp_f32_e64 v133, v133
  v_mfma_f32_16x16x32_bf16 v[102:105], v[24:27], v[62:65], v[102:105]
  v_cvt_pk_bf16_f32 v66, v126, v127
  v_cvt_pk_bf16_f32 v67, v128, v129
  v_cvt_pk_bf16_f32 v68, v130, v131
  v_cvt_pk_bf16_f32 v69, v132, v133
  buffer_load_dwordx4 a[216:219], v2, s[84:87], s32 offen offset:2048 sc1
  v_exp_f32 v134, v134
  v_exp_f32 v135, v135
  v_exp_f32 v136, v136
  v_exp_f32 v137, v137
  s_waitcnt lgkmcnt(3)
  v_mfma_f32_32x32x16_bf16 v[86:101], a[76:79], v[66:69], v[86:101]
  v_exp_f32 v138, v138
  v_exp_f32 v139, v139
  v_exp_f32 v140, v140
  v_exp_f32 v141, v141
  v_mfma_f32_16x16x32_bf16 v[102:105], v[24:27], v[66:69], v[102:105]
  buffer_load_dwordx4 a[156:159], v2, s[84:87], s31 offen offset:3072 sc1
  s_add_u32 s31, s31, 4096
  v_cvt_pk_bf16_f32 v78, v134, v135
  v_cvt_pk_bf16_f32 v79, v136, v137
  v_mfma_f32_32x32x16_bf16 v[118:133], a[40:43], v[34:37], v[182:197]
  v_cvt_pk_bf16_f32 v80, v138, v139
  v_cvt_pk_bf16_f32 v81, v140, v141
  ds_read_b128 a[92:95], v23 offset:11264
  v_exp_f32 v142, v142
  v_exp_f32 v143, v143
  v_exp_f32 v144, v144
  v_exp_f32 v145, v145
  v_mfma_f32_32x32x16_bf16 v[214:229], a[72:75], v[78:81], v[214:229]
  buffer_load_dwordx4 a[220:223], v2, s[84:87], s32 offen offset:3072 sc1
  s_add_u32 s32, s32, 4096
  v_exp_f32 v146, v146
  v_exp_f32 v147, v147
  v_exp_f32 v148, v148
  v_exp_f32_e64 v149, v149
  v_mfma_f32_16x16x32_bf16 v[106:109], v[24:27], v[78:81], v[106:109]
  v_cvt_pk_bf16_f32 v82, v142, v143
  v_cvt_pk_bf16_f32 v83, v144, v145
  v_cvt_pk_bf16_f32 v84, v146, v147
  v_cvt_pk_bf16_f32 v85, v148, v149
  buffer_load_dwordx4 a[160:163], v2, s[84:87], s31 offen offset:0 sc1
  s_nop 0
  v_mfma_f32_16x16x32_bf16 v[106:109], v[24:27], v[82:85], v[106:109]
  v_mfma_f32_32x32x16_bf16 v[214:229], a[76:79], v[82:85], v[214:229]
Lend_37:
  s_cmp_lt_u32 s30, 5
  s_cbranch_scc1 Lsk_38
  v_exp_f32 v118, v118
  v_exp_f32 v119, v119
  v_exp_f32 v120, v120
  v_exp_f32 v121, v121
  v_mfma_f32_32x32x16_bf16 v[134:149], a[44:47], v[38:41], v[198:213]
  v_exp_f32 v122, v122
  v_exp_f32 v123, v123
  v_exp_f32 v124, v124
  v_exp_f32_e64 v125, v125
  buffer_load_dwordx4 a[224:227], v2, s[84:87], s32 offen offset:0 sc1
  v_cvt_pk_bf16_f32 v62, v118, v119
  v_cvt_pk_bf16_f32 v63, v120, v121
  v_cvt_pk_bf16_f32 v64, v122, v123
  v_cvt_pk_bf16_f32 v65, v124, v125
  ds_read_b128 a[96:99], v23 offset:6144
  v_exp_f32 v126, v126
  v_exp_f32 v127, v127
  v_exp_f32 v128, v128
  v_exp_f32 v129, v129
  s_waitcnt lgkmcnt(4)
  v_mfma_f32_32x32x16_bf16 v[86:101], a[80:83], v[62:65], v[86:101]
  buffer_load_dwordx4 a[164:167], v2, s[84:87], s31 offen offset:1024 sc1
  v_exp_f32 v130, v130
  v_exp_f32 v131, v131
  v_exp_f32 v132, v132
  v_exp_f32_e64 v133, v133
  v_mfma_f32_16x16x32_bf16 v[102:105], v[24:27], v[62:65], v[102:105]
  v_cvt_pk_bf16_f32 v66, v126, v127
  v_cvt_pk_bf16_f32 v67, v128, v129
  v_cvt_pk_bf16_f32 v68, v130, v131
  v_cvt_pk_bf16_f32 v69, v132, v133
  buffer_load_dwordx4 a[228:231], v2, s[84:87], s32 offen offset:1024 sc1
  v_exp_f32 v134, v134
  v_exp_f32 v135, v135
  v_exp_f32 v136, v136
  v_exp_f32 v137, v137
  s_waitcnt lgkmcnt(3)
  v_mfma_f32_32x32x16_bf16 v[86:101], a[84:87], v[66:69], v[86:101]
  v_exp_f32 v138, v138
  v_exp_f32 v139, v139
  v_exp_f32 v140, v140
  v_exp_f32 v141, v141
  v_mfma_f32_16x16x32_bf16 v[102:105], v[24:27], v[66:69], v[102:105]
  buffer_load_dwordx4 a[168:171], v2, s[84:87], s31 offen offset:2048 sc1
  v_cvt_pk_bf16_f32 v78, v134, v135
  v_cvt_pk_bf16_f32 v79, v136, v137
  v_mfma_f32_32x32x16_bf16 v[118:133], a[48:51], v[34:37], v[182:197]
  v_cvt_pk_bf16_f32 v80, v138, v139
  v_cvt_pk_bf16_f32 v81, v140, v141
  ds_read_b128 a[100:103], v23 offset:7168
  v_exp_f32 v142, v142
  v_exp_f32 v143, v143
  v_exp_f32 v144, v144
  v_exp_f32 v145, v145
  v_mfma_f32_32x32x16_bf16 v[214:229], a[80:83], v[78:81], v[214:229]
  buffer_load_dwordx4 a[232:235], v2, s[84:87], s32 offen offset:2048 sc1
  v_exp_f32 v146, v146
  v_exp_f32 v147, v147
  v_exp_f32 v148, v148
  v_exp_f32_e64 v149, v149
  v_mfma_f32_16x16x32_bf16 v[106:109], v[24:27], v[78:81], v[106:109]
  v_cvt_pk_bf16_f32 v82, v142, v143
  v_cvt_pk_bf16_f32 v83, v144, v145
  v_cvt_pk_bf16_f32 v84, v146, v147
  v_cvt_pk_bf16_f32 v85, v148, v149
  buffer_load_dwordx4 a[172:175], v2, s[84:87], s31 offen offset:3072 sc1
  s_add_u32 s31, s31, 4096
  v_mfma_f32_16x16x32_bf16 v[106:109], v[24:27], v[82:85], v[106:109]
  v_mfma_f32_32x32x16_bf16 v[214:229], a[84:87], v[82:85], v[214:229]
Lend_39:
  s_cmp_lt_u32 s30, 6
  s_cbranch_scc1 Lsk_40
  v_exp_f32 v118, v118
  v_exp_f32 v119, v119
  v_exp_f32 v120, v120
  v_exp_f32 v121, v121
  v_mfma_f32_32x32x16_bf16 v[134:149], a[52:55], v[38:41], v[198:213]
  v_exp_f32 v122, v122
  v_exp_f32 v123, v123
  v_exp_f32 v124, v124
  v_exp_f32 v125, v125
  buffer_load_dwordx4 a[236:239], v2, s[84:87], s32 offen offset:3072 sc1
  s_add_u32 s32, s32, 4096
  v_cvt_pk_bf16_f32 v62, v118, v119
  v_cvt_pk_bf16_f32 v63, v120, v121
  v_cvt_pk_bf16_f32 v64, v122, v123
  v_cvt_pk_bf16_f32 v65, v124, v125
  ds_read_b128 a[72:75], v23 offset:2048
  v_exp_f32 v126, v126
  v_exp_f32 v127, v127
  v_exp_f32 v128, v128
  v_exp_f32 v129, v129
  s_waitcnt lgkmcnt(4)
  v_mfma_f32_32x32x16_bf16 v[86:101], a[88:91], v[62:65], v[86:101]
  buffer_load_dwordx4 a[176:179], v2, s[84:87], s31 offen offset:0 sc1
  v_exp_f32 v130, v130
  v_exp_f32 v131, v131
  v_exp_f32 v132, v132
  v_exp_f32_e64 v133, v133
  v_mfma_f32_16x16x32_bf16 v[102:105], v[24:27], v[62:65], v[102:105]
  v_cvt_pk_bf16_f32 v66, v126, v127
  v_cvt_pk_bf16_f32 v67, v128, v129
  v_cvt_pk_bf16_f32 v68, v130, v131
  v_cvt_pk_bf16_f32 v69, v132, v133
  buffer_load_dwordx4 a[240:243], v2, s[84:87], s32 offen offset:0 sc1
  v_exp_f32 v134, v134
  v_exp_f32 v135, v135
  v_exp_f32 v136, v136
  v_exp_f32 v137, v137
  s_waitcnt lgkmcnt(3)
  v_mfma_f32_32x32x16_bf16 v[86:101], a[92:95], v[66:69], v[86:101]
  v_exp_f32 v138, v138
  v_exp_f32 v139, v139
  v_exp_f32 v140, v140
  v_exp_f32 v141, v141
  v_mfma_f32_16x16x32_bf16 v[102:105], v[24:27], v[66:69], v[102:105]
  buffer_load_dwordx4 a[180:183], v2, s[84:87], s31 offen offset:1024 sc1
  v_cvt_pk_bf16_f32 v78, v134, v135
  v_cvt_pk_bf16_f32 v79, v136, v137
  v_mfma_f32_32x32x16_bf16 v[118:133], a[56:59], v[34:37], v[182:197]
  v_cvt_pk_bf16_f32 v80, v138, v139
  v_cvt_pk_bf16_f32 v81, v140, v141
  ds_read_b128 a[76:79], v23 offset:3072
  v_exp_f32 v142, v142
  v_exp_f32 v143, v143
  v_exp_f32 v144, v144
  v_exp_f32 v145, v145
  v_mfma_f32_32x32x16_bf16 v[214:229], a[88:91], v[78:81], v[214:229]
  buffer_load_dwordx4 a[244:247], v2, s[84:87], s32 offen offset:1024 sc1
  v_exp_f32 v146, v146
  v_exp_f32 v147, v147
  v_exp_f32 v148, v148
  v_exp_f32_e64 v149, v149
  v_mfma_f32_16x16x32_bf16 v[106:109], v[24:27], v[78:81], v[106:109]
  v_cvt_pk_bf16_f32 v82, v142, v143
  v_cvt_pk_bf16_f32 v83, v144, v145
  v_cvt_pk_bf16_f32 v84, v146, v147
  v_cvt_pk_bf16_f32 v85, v148, v149
  buffer_load_dwordx4 a[184:187], v2, s[84:87], s31 offen offset:2048 sc1
  s_nop 0
  v_mfma_f32_16x16x32_bf16 v[106:109], v[24:27], v[82:85], v[106:109]
  v_mfma_f32_32x32x16_bf16 v[214:229], a[92:95], v[82:85], v[214:229]
Lend_41:
  buffer_load_dwordx4 v[58:61], v2, s[84:87], s77 offen sc1
  s_cmp_lt_u32 s30, 7
  s_cbranch_scc1 Lsk_42
  v_exp_f32 v118, v118
  v_exp_f32 v119, v119
  v_exp_f32 v120, v120
  v_exp_f32 v121, v121
  v_mfma_f32_32x32x16_bf16 v[134:149], a[60:63], v[38:41], v[198:213]
  v_exp_f32 v122, v122
  v_exp_f32 v123, v123
  v_exp_f32 v124, v124
  v_exp_f32_e64 v125, v125
  v_cvt_pk_bf16_f32 v62, v118, v119
  v_cvt_pk_bf16_f32 v63, v120, v121
  v_cvt_pk_bf16_f32 v64, v122, v123
  v_cvt_pk_bf16_f32 v65, v124, v125
  v_exp_f32 v126, v126
  v_exp_f32 v127, v127
  v_exp_f32 v128, v128
  v_exp_f32 v129, v129
  s_waitcnt lgkmcnt(3)
  v_mfma_f32_32x32x16_bf16 v[86:101], a[96:99], v[62:65], v[86:101]
  buffer_load_dwordx4 a[248:251], v2, s[84:87], s32 offen offset:2048 sc1
  v_exp_f32 v130, v130
  v_exp_f32 v131, v131
  v_exp_f32 v132, v132
  v_exp_f32_e64 v133, v133
  v_mfma_f32_16x16x32_bf16 v[102:105], v[24:27], v[62:65], v[102:105]
  v_cvt_pk_bf16_f32 v66, v126, v127
  v_cvt_pk_bf16_f32 v67, v128, v129
  v_cvt_pk_bf16_f32 v68, v130, v131
  v_cvt_pk_bf16_f32 v69, v132, v133
  v_exp_f32 v134, v134
  v_exp_f32 v135, v135
  v_exp_f32 v136, v136
  v_exp_f32 v137, v137
  s_waitcnt lgkmcnt(2)
  v_mfma_f32_32x32x16_bf16 v[86:101], a[100:103], v[66:69], v[86:101]
  v_exp_f32 v138, v138
  v_exp_f32 v139, v139
  v_exp_f32 v140, v140
  v_exp_f32_e64 v141, v141
  v_mfma_f32_16x16x32_bf16 v[102:105], v[24:27], v[66:69], v[102:105]
  buffer_load_dwordx4 a[188:191], v2, s[84:87], s31 offen offset:3072 sc1
  s_add_u32 s31, s31, 4096
  v_cvt_pk_bf16_f32 v78, v134, v135
  v_cvt_pk_bf16_f32 v79, v136, v137
  v_cvt_pk_bf16_f32 v80, v138, v139
  v_cvt_pk_bf16_f32 v81, v140, v141
  v_exp_f32 v142, v142
  v_exp_f32 v143, v143
  v_exp_f32 v144, v144
  v_exp_f32 v145, v145
  v_mfma_f32_32x32x16_bf16 v[214:229], a[96:99], v[78:81], v[214:229]
  v_exp_f32 v146, v146
  v_exp_f32 v147, v147
  v_exp_f32 v148, v148
  v_exp_f32 v149, v149
  v_mfma_f32_16x16x32_bf16 v[106:109], v[24:27], v[78:81], v[106:109]
  v_cvt_pk_bf16_f32 v82, v142, v143
  v_cvt_pk_bf16_f32 v83, v144, v145
  v_cvt_pk_bf16_f32 v84, v146, v147
  v_cvt_pk_bf16_f32 v85, v148, v149
  buffer_load_dwordx4 a[252:255], v2, s[84:87], s32 offen offset:3072 sc1
  s_add_u32 s32, s32, 4096
  v_mfma_f32_16x16x32_bf16 v[106:109], v[24:27], v[82:85], v[106:109]
  v_mfma_f32_32x32x16_bf16 v[214:229], a[100:103], v[82:85], v[214:229]
Lend_43:
  s_cmp_lt_u32 s30, 8
  s_cbranch_scc1 Lend_44
  s_waitcnt lgkmcnt(1)
  v_mfma_f32_32x32x16_bf16 v[86:101], a[72:75], v[150:153], v[86:101]
  v_mfma_f32_32x32x16_bf16 v[214:229], a[72:75], v[166:169], v[214:229]
  s_waitcnt lgkmcnt(0)
  v_mfma_f32_32x32x16_bf16 v[86:101], a[76:79], v[154:157], v[86:101]
  v_mfma_f32_32x32x16_bf16 v[214:229], a[76:79], v[170:173], v[214:229]
Lend_44:
  s_waitcnt lgkmcnt(0)
  v_rcp_f32 v32, v102
  s_nop 2
  v_rcp_f32_e64 v33, v106
  s_nop 4
  v_pk_mul_f32 v[86:87], v[86:87], v[32:33] op_sel_hi:[1,0]
  v_pk_mul_f32 v[88:89], v[88:89], v[32:33] op_sel_hi:[1,0]
  v_pk_mul_f32 v[90:91], v[90:91], v[32:33] op_sel_hi:[1,0]
  v_pk_mul_f32 v[92:93], v[92:93], v[32:33] op_sel_hi:[1,0]
  v_cvt_pk_bf16_f32 v110, v86, v87
  v_cvt_pk_bf16_f32 v111, v88, v89
  v_cvt_pk_bf16_f32 v112, v90, v91
  v_cvt_pk_bf16_f32 v113, v92, v93
  v_pk_mul_f32 v[222:223], v[222:223], v[32:33] op_sel:[0,1] op_sel_hi:[1,1]
  v_pk_mul_f32 v[224:225], v[224:225], v[32:33] op_sel:[0,1] op_sel_hi:[1,1]
  v_pk_mul_f32 v[226:227], v[226:227], v[32:33] op_sel:[0,1] op_sel_hi:[1,1]
  v_pk_mul_f32 v[228:229], v[228:229], v[32:33] op_sel:[0,1] op_sel_hi:[1,1]
  v_cvt_pk_bf16_f32 v114, v222, v223
  v_cvt_pk_bf16_f32 v115, v224, v225
  v_cvt_pk_bf16_f32 v116, v226, v227
  v_cvt_pk_bf16_f32 v117, v228, v229
  s_cmp_eq_u32 s96, 0
  s_cbranch_scc1 Lslow_45
  buffer_store_dwordx4 v[110:113], v2, s[84:87], s76 offen
  buffer_store_dwordx4 v[114:117], v2, s[84:87], s76 offen offset:1024
Lse_46:
  v_and_b32 v8, 31, v1
  v_and_b32 v9, 32, v1
  v_lshl_add_u32 v8, v8, 6, v9
  s_add_u32 s98, s24, 98304
  v_add_u32 v8, s98, v8
  s_waitcnt vmcnt(61)
  ds_read_b128 v[230:233], v8
  ds_read_b128 v[234:237], v8 offset:16
  s_waitcnt vmcnt(5)
  v_xor_b32 v58, v3, v58
  v_bitop3_b32 v58, v58, v59, v3 bitop3:0xf6
  v_bitop3_b32 v58, v58, v60, v3 bitop3:0xf6
  v_bitop3_b32 v58, v58, v61, v3 bitop3:0xf6
  v_cmp_ne_u32 vcc, 0, v58
  s_nop 0
  s_cmp_lg_u64 vcc, 0
  s_cbranch_scc1 Lre_47
Lok_48:
  buffer_load_dwordx4 a[0:3], v2, s[84:87], s33 offen offset:0 sc1
  buffer_load_dwordx4 a[4:7], v2, s[84:87], s34 offen offset:0 sc1
  buffer_load_dwordx4 a[8:11], v2, s[84:87], s33 offen offset:1024 sc1
  buffer_load_dwordx4 a[12:15], v2, s[84:87], s34 offen offset:1024 sc1
  buffer_load_dwordx4 a[16:19], v2, s[84:87], s33 offen offset:2048 sc1
  buffer_load_dwordx4 a[20:23], v2, s[84:87], s34 offen offset:2048 sc1
  v_mov_b32 v55, v76
  s_mul_i32 s98, s92, 7
  s_lshr_b32 s98, s98, 1
  s_lshl_b32 s98, s98, 4
  s_lshl_b32 s99, s8, 3
  s_add_u32 s98, s98, s99
  s_lshl_b32 s99, s93, 10
  s_add_u32 s98, s98, s99
  v_and_b32 v50, 3, v1
  v_lshl_add_u32 v50, v50, 4, s98
  v_and_b32 v8, 4, v1
  v_add_u32 v50, v50, v8
  v_and_b32 v76, 7, v1
  s_lshl_b32 s98, s21, 6
  s_lshl_b32 s4, s9, 5
  s_add_u32 s98, s98, s4
  v_lshl_add_u32 v76, v76, 2, s98
  s_lshl_b32 s25, s21, 15
  s_lshl_b32 s4, s9, 14
  s_add_u32 s25, s25, s4
  s_add_u32 s25, s25, 0x300000
  v_lshrrev_b32 v8, 5, v1
  v_lshl_add_u32 v51, v57, 7, v54
  v_and_b32 v10, 8, v1
  v_lshl_add_u32 v51, v10, 3, v51
  v_xor_b32 v52, 64, v51
  v_add_u32 v71, 65536, v51
  v_add_u32 v72, 65536, v52
  v_and_b32 v10, 31, v1
  v_min_u32 v10, 2, v10
  v_lshlrev_b32 v74, 10, v10
  v_lshl_add_u32 v74, v8, 4, v74
  v_add_u32 v74, 156672, v74
  s_lshl_b32 s98, s10, 11
  s_lshl_b32 s4, s9, 6
  s_add_u32 s98, s98, s4
  v_xor_b32 v73, s98, v51
  s_lshl_b32 s98, s9, 7
  s_add_u32 s98, s98, 0x26000
  v_lshl_add_u32 v75, v8, 6, s98
  ds_read_b128 v[118:121], v75 offset:0
  ds_read_b128 v[122:125], v75 offset:16
  ds_read_b128 v[126:129], v75 offset:32
  ds_read_b128 v[130:133], v75 offset:48
  ds_read_b128 v[134:137], v75 offset:256
  ds_read_b128 v[138:141], v75 offset:272
  ds_read_b128 v[142:145], v75 offset:288
  ds_read_b128 v[146:149], v75 offset:304
  ds_read_b128 v[150:153], v75 offset:512
  ds_read_b128 v[154:157], v75 offset:528
  ds_read_b128 v[158:161], v75 offset:544
  ds_read_b128 v[162:165], v75 offset:560
  s_waitcnt vmcnt(6)
  s_add_u32 s4, s75, 0x2000
  s_mov_b64 exec, 1
  s_cmp_eq_u32 s96, 0
  s_cbranch_scc1 Lslow_50
  buffer_store_dword v3, v4, s[84:87], s4 offen
Lse_51:
  s_mov_b64 exec, -1
  s_waitcnt lgkmcnt(12)
  s_barrier
  s_movk_i32 s26, 8192
  ds_read_b128 v[58:61], v74 offset:0
  ds_read_b64_tr_b16 v[62:63], v73 offset:0
  ds_read_b64_tr_b16 v[64:65], v73 offset:512
  ds_read_b128 v[16:19], v74 offset:32
  ds_read_b64_tr_b16 v[20:21], v73 offset:4096
  ds_read_b64_tr_b16 v[22:23], v73 offset:4608
  ds_read_b128 v[24:27], v74 offset:64
  ds_read_b64_tr_b16 v[28:29], v73 offset:8192
  ds_read_b64_tr_b16 v[30:31], v73 offset:8704
  ds_read_b128 v[32:35], v74 offset:96
  ds_read_b64_tr_b16 v[36:37], v73 offset:12288
  ds_read_b64_tr_b16 v[38:39], v73 offset:12800
  s_waitcnt lgkmcnt(9)
  v_mfma_f32_32x32x16_bf16 v[238:253], v[58:61], v[62:65], 0
  buffer_load_dwordx4 v77, s[56:59], s37 offen offset:0 lds
  ds_read_b128 v[58:61], v74 offset:128
  ds_read_b64_tr_b16 v[62:63], v73 offset:16384
  ds_read_b64_tr_b16 v[64:65], v73 offset:16896
  s_waitcnt lgkmcnt(9)
  v_mfma_f32_32x32x16_bf16 v[238:253], v[16:19], v[20:23], v[238:253]
  buffer_load_dwordx4 v56, s[56:59], s37 offen offset:1024 lds
  ds_read_b128 v[16:19], v74 offset:160
  ds_read_b64_tr_b16 v[20:21], v73 offset:20480
  ds_read_b64_tr_b16 v[22:23], v73 offset:20992
  s_waitcnt lgkmcnt(9)
  v_mfma_f32_32x32x16_bf16 v[238:253], v[24:27], v[28:31], v[238:253]
  buffer_load_dwordx4 v12, s[56:59], s37 offen offset:2048 lds
  ds_read_b128 v[24:27], v74 offset:192
  ds_read_b64_tr_b16 v[28:29], v73 offset:24576
  ds_read_b64_tr_b16 v[30:31], v73 offset:25088
  s_waitcnt lgkmcnt(9)
  v_mfma_f32_32x32x16_bf16 v[238:253], v[32:35], v[36:39], v[238:253]
  buffer_load_dwordx4 v13, s[56:59], s37 offen offset:3072 lds
  s_add_u32 m0, m0, 16384
  s_add_u32 s37, s37, 229376
  ds_read_b128 v[32:35], v74 offset:224
  ds_read_b64_tr_b16 v[36:37], v73 offset:28672
  ds_read_b64_tr_b16 v[38:39], v73 offset:29184
  s_waitcnt lgkmcnt(9)
  v_mfma_f32_32x32x16_bf16 v[238:253], v[58:61], v[62:65], v[238:253]
  buffer_load_dwordx4 v77, s[56:59], s37 offen offset:0 lds
  ds_read_b128 v[58:61], v74 offset:256
  ds_read_b64_tr_b16 v[62:63], v73 offset:32768
  ds_read_b64_tr_b16 v[64:65], v73 offset:33280
  s_waitcnt lgkmcnt(9)
  v_mfma_f32_32x32x16_bf16 v[238:253], v[16:19], v[20:23], v[238:253]
  buffer_load_dwordx4 v56, s[56:59], s37 offen offset:1024 lds
  ds_read_b128 v[16:19], v74 offset:288
  ds_read_b64_tr_b16 v[20:21], v73 offset:36864
  ds_read_b64_tr_b16 v[22:23], v73 offset:37376
  s_waitcnt lgkmcnt(9)
  v_mfma_f32_32x32x16_bf16 v[238:253], v[24:27], v[28:31], v[238:253]
  buffer_load_dwordx4 v12, s[56:59], s37 offen offset:2048 lds
  ds_read_b128 v[24:27], v74 offset:320
  ds_read_b64_tr_b16 v[28:29], v73 offset:40960
  ds_read_b64_tr_b16 v[30:31], v73 offset:41472
  s_waitcnt lgkmcnt(9)
  v_mfma_f32_32x32x16_bf16 v[238:253], v[32:35], v[36:39], v[238:253]
  buffer_load_dwordx4 v13, s[56:59], s37 offen offset:3072 lds
  s_add_u32 m0, m0, 16384
  s_add_u32 s37, s37, 229376
  buffer_load_dword v54, v76, s[84:87], s26 offen sc1
  ds_read_b128 v[32:35], v74 offset:352
  ds_read_b64_tr_b16 v[36:37], v73 offset:45056
  ds_read_b64_tr_b16 v[38:39], v73 offset:45568
  s_waitcnt lgkmcnt(9)
  v_mfma_f32_32x32x16_bf16 v[238:253], v[58:61], v[62:65], v[238:253]
  ds_read_b128 v[58:61], v74 offset:384
  ds_read_b64_tr_b16 v[62:63], v73 offset:49152
  ds_read_b64_tr_b16 v[64:65], v73 offset:49664
  s_waitcnt lgkmcnt(9)
  v_mfma_f32_32x32x16_bf16 v[238:253], v[16:19], v[20:23], v[238:253]
  ds_read_b128 v[16:19], v74 offset:416
  ds_read_b64_tr_b16 v[20:21], v73 offset:53248
  ds_read_b64_tr_b16 v[22:23], v73 offset:53760
  s_waitcnt lgkmcnt(9)
  v_mfma_f32_32x32x16_bf16 v[238:253], v[24:27], v[28:31], v[238:253]
  ds_read_b128 v[24:27], v74 offset:448
  ds_read_b64_tr_b16 v[28:29], v73 offset:57344
  ds_read_b64_tr_b16 v[30:31], v73 offset:57856
  s_waitcnt lgkmcnt(9)
  v_mfma_f32_32x32x16_bf16 v[238:253], v[32:35], v[36:39], v[238:253]
  ds_read_b128 v[32:35], v74 offset:480
  ds_read_b64_tr_b16 v[36:37], v73 offset:61440
  ds_read_b64_tr_b16 v[38:39], v73 offset:61952
  s_waitcnt lgkmcnt(9)
  v_mfma_f32_32x32x16_bf16 v[238:253], v[58:61], v[62:65], v[238:253]
  s_waitcnt vmcnt(0)
  v_cmp_ne_u32 vcc, s95, v54
  s_nop 0
  s_cmp_lg_u64 vcc, 0
  s_cbranch_scc1 Lre_52
Lok_53:
  buffer_load_dwordx4 v[166:169], v2, s[84:87], s25 offen offset:0 sc1
  buffer_load_dwordx4 v[170:173], v2, s[84:87], s25 offen offset:1024 sc1
  buffer_load_dwordx4 v[174:177], v2, s[84:87], s25 offen offset:2048 sc1
  buffer_load_dwordx4 v[178:181], v2, s[84:87], s25 offen offset:3072 sc1
  s_add_u32 s25, s25, 4096
  s_waitcnt lgkmcnt(6)
  v_mfma_f32_32x32x16_bf16 v[238:253], v[16:19], v[20:23], v[238:253]
  buffer_load_dwordx4 v[182:185], v2, s[84:87], s25 offen offset:0 sc1
  s_waitcnt lgkmcnt(3)
  v_mfma_f32_32x32x16_bf16 v[238:253], v[24:27], v[28:31], v[238:253]
  buffer_load_dwordx4 v[186:189], v2, s[84:87], s25 offen offset:1024 sc1
  s_waitcnt lgkmcnt(0)
  v_mfma_f32_32x32x16_bf16 v[238:253], v[32:35], v[36:39], v[238:253]
  buffer_load_dwordx4 v[190:193], v2, s[84:87], s25 offen offset:2048 sc1
  buffer_load_dwordx4 v[194:197], v2, s[84:87], s25 offen offset:3072 sc1
  s_add_u32 s25, s25, 4096
  buffer_load_dwordx4 v[198:201], v2, s[84:87], s25 offen offset:0 sc1
  buffer_load_dwordx4 v[202:205], v2, s[84:87], s25 offen offset:1024 sc1
  v_lshlrev_b32 v16, 16, v230
  v_and_b32 v17, 0xffff0000, v230
  v_lshlrev_b32 v18, 16, v231
  v_and_b32 v19, 0xffff0000, v231
  v_lshlrev_b32 v20, 16, v232
  v_and_b32 v21, 0xffff0000, v232
  v_lshlrev_b32 v22, 16, v233
  v_and_b32 v23, 0xffff0000, v233
  v_lshlrev_b32 v24, 16, v234
  v_and_b32 v25, 0xffff0000, v234
  v_lshlrev_b32 v26, 16, v235
  v_and_b32 v27, 0xffff0000, v235
  v_lshlrev_b32 v28, 16, v236
  v_and_b32 v29, 0xffff0000, v236
  v_lshlrev_b32 v30, 16, v237
  v_and_b32 v31, 0xffff0000, v237
  s_lshl_b32 s98, s92, 12
  s_add_u32 s98, s98, 0x20000
  v_add_u32 v254, s98, v2
  v_xor_b32 v255, 4096, v254
  s_lshl_b32 s5, s21, 15
  s_lshl_b32 s4, s79, 12
  s_add_u32 s5, s5, s4
  s_lshl_b32 s4, s9, 11
  s_add_u32 s5, s5, s4
  s_add_u32 s5, s5, 0x100000
  s_mov_b32 s6, s12
  s_add_u32 s6, s6, 0x1000
  s_waitcnt vmcnt(9)
  v_mfma_f32_32x32x16_bf16 v[94:109], a[192:195], v[166:169], 0
  buffer_load_dwordx4 v[206:209], v2, s[84:87], s25 offen offset:2048 sc1
  s_waitcnt vmcnt(9)
  v_mfma_f32_32x32x16_bf16 v[94:109], a[196:199], v[170:173], v[94:109]
  buffer_load_dwordx4 v[210:213], v2, s[84:87], s25 offen offset:3072 sc1
  s_add_u32 s25, s25, 4096
  s_waitcnt vmcnt(9)
  v_mfma_f32_32x32x16_bf16 v[94:109], a[200:203], v[174:177], v[94:109]
  buffer_load_dwordx4 v[214:217], v2, s[84:87], s25 offen offset:0 sc1
  s_waitcnt vmcnt(9)
  v_mfma_f32_32x32x16_bf16 v[94:109], a[204:207], v[178:181], v[94:109]
  buffer_load_dwordx4 v[218:221], v2, s[84:87], s25 offen offset:1024 sc1
  s_waitcnt vmcnt(9)
  v_mfma_f32_32x32x16_bf16 v[94:109], a[208:211], v[182:185], v[94:109]
  buffer_load_dwordx4 v[222:225], v2, s[84:87], s25 offen offset:2048 sc1
  v_mfma_f32_32x32x16_bf16 v[78:93], a[128:131], v[166:169], 0
  s_waitcnt vmcnt(9)
  v_mfma_f32_32x32x16_bf16 v[94:109], a[212:215], v[186:189], v[94:109]
  buffer_load_dwordx4 v[226:229], v2, s[84:87], s25 offen offset:3072 sc1
  s_add_u32 s25, s25, 4096
  v_mfma_f32_32x32x16_bf16 v[78:93], a[132:135], v[170:173], v[78:93]
  s_waitcnt vmcnt(9)
  v_mfma_f32_32x32x16_bf16 v[94:109], a[216:219], v[190:193], v[94:109]
  buffer_load_dwordx4 a[24:27], v2, s[84:87], s33 offen offset:3072 sc1
  s_add_u32 s33, s33, 8192
  v_mfma_f32_32x32x16_bf16 v[78:93], a[136:139], v[174:177], v[78:93]
  s_waitcnt vmcnt(9)
  v_mfma_f32_32x32x16_bf16 v[94:109], a[220:223], v[194:197], v[94:109]
  buffer_load_dwordx4 a[28:31], v2, s[84:87], s34 offen offset:3072 sc1
  s_add_u32 s34, s34, 8192
  v_mfma_f32_32x32x16_bf16 v[78:93], a[140:143], v[178:181], v[78:93]
  s_waitcnt vmcnt(9)
  v_mfma_f32_32x32x16_bf16 v[94:109], a[224:227], v[198:201], v[94:109]
  buffer_load_dwordx4 a[32:35], v2, s[84:87], s33 offen offset:0 sc1
  v_mfma_f32_32x32x16_bf16 v[78:93], a[144:147], v[182:185], v[78:93]
  s_waitcnt vmcnt(9)
  v_mfma_f32_32x32x16_bf16 v[94:109], a[228:231], v[202:205], v[94:109]
  v_mfma_f32_32x32x16_bf16 v[78:93], a[148:151], v[186:189], v[78:93]
  s_waitcnt vmcnt(8)
  v_mfma_f32_32x32x16_bf16 v[94:109], a[232:235], v[206:209], v[94:109]
  v_mfma_f32_32x32x16_bf16 v[78:93], a[152:155], v[190:193], v[78:93]
  s_waitcnt vmcnt(7)
  v_mfma_f32_32x32x16_bf16 v[94:109], a[236:239], v[210:213], v[94:109]
  v_mfma_f32_32x32x16_bf16 v[78:93], a[156:159], v[194:197], v[78:93]
  s_waitcnt vmcnt(6)
  v_mfma_f32_32x32x16_bf16 v[94:109], a[240:243], v[214:217], v[94:109]
  v_mfma_f32_32x32x16_bf16 v[78:93], a[160:163], v[198:201], v[78:93]
  s_waitcnt vmcnt(5)
  v_mfma_f32_32x32x16_bf16 v[94:109], a[244:247], v[218:221], v[94:109]
  v_mfma_f32_32x32x16_bf16 v[78:93], a[164:167], v[202:205], v[78:93]
  s_waitcnt vmcnt(4)
  v_mfma_f32_32x32x16_bf16 v[94:109], a[248:251], v[222:225], v[94:109]
  v_mfma_f32_32x32x16_bf16 v[78:93], a[168:171], v[206:209], v[78:93]
  s_waitcnt vmcnt(3)
  v_mfma_f32_32x32x16_bf16 v[94:109], a[252:255], v[226:229], v[94:109]
  v_mfma_f32_32x32x16_bf16 v[78:93], a[172:175], v[210:213], v[78:93]
  v_mfma_f32_32x32x16_bf16 v[78:93], a[176:179], v[214:217], v[78:93]
  v_mfma_f32_32x32x16_bf16 v[78:93], a[180:183], v[218:221], v[78:93]
  s_nop 8
  ds_write_b128 v255, v[94:97] offset:0
  ds_write_b128 v255, v[98:101] offset:1024
  v_mfma_f32_32x32x16_bf16 v[78:93], a[184:187], v[222:225], v[78:93]
  ds_write_b128 v255, v[102:105] offset:2048
  ds_write_b128 v255, v[106:109] offset:3072
  v_mfma_f32_32x32x16_bf16 v[78:93], a[188:191], v[226:229], v[78:93]
  s_waitcnt lgkmcnt(0)
  s_barrier
  ds_read_b128 v[94:97], v254 offset:0
  ds_read_b128 v[98:101], v254 offset:1024
  ds_read_b128 v[102:105], v254 offset:2048
  ds_read_b128 v[106:109], v254 offset:3072
  s_nop 5
  v_pk_fma_f32 v[16:17], v[78:79], v[118:119], v[16:17]
  v_pk_fma_f32 v[18:19], v[80:81], v[120:121], v[18:19]
  v_pk_fma_f32 v[20:21], v[82:83], v[122:123], v[20:21]
  v_pk_fma_f32 v[22:23], v[84:85], v[124:125], v[22:23]
  v_pk_fma_f32 v[24:25], v[86:87], v[126:127], v[24:25]
  v_pk_fma_f32 v[26:27], v[88:89], v[128:129], v[26:27]
  v_pk_fma_f32 v[28:29], v[90:91], v[130:131], v[28:29]
  v_pk_fma_f32 v[30:31], v[92:93], v[132:133], v[30:31]
  s_waitcnt lgkmcnt(3)
  v_pk_fma_f32 v[16:17], v[94:95], v[118:119], v[16:17]
  v_pk_fma_f32 v[18:19], v[96:97], v[120:121], v[18:19]
  s_waitcnt lgkmcnt(2)
  v_pk_fma_f32 v[20:21], v[98:99], v[122:123], v[20:21]
  v_pk_fma_f32 v[22:23], v[100:101], v[124:125], v[22:23]
  v_cvt_pk_bf16_f32 v230, v16, v17
  v_cvt_pk_bf16_f32 v231, v18, v19
  v_cvt_pk_bf16_f32 v232, v20, v21
  v_cvt_pk_bf16_f32 v233, v22, v23
  v_lshlrev_b32 v16, 16, v230
  v_and_b32 v17, 0xffff0000, v230
  v_lshlrev_b32 v18, 16, v231
  v_and_b32 v19, 0xffff0000, v231
  v_lshlrev_b32 v20, 16, v232
  v_and_b32 v21, 0xffff0000, v232
  v_lshlrev_b32 v22, 16, v233
  v_and_b32 v23, 0xffff0000, v233
  v_pk_mul_f32 v[166:167], v[16:17], v[150:151]
  v_pk_mul_f32 v[168:169], v[18:19], v[152:153]
  v_pk_mul_f32 v[170:171], v[20:21], v[154:155]
  v_pk_mul_f32 v[172:173], v[22:23], v[156:157]
  v_cvt_pk_bf16_f32 v230, v166, v167
  v_cvt_pk_bf16_f32 v231, v168, v169
  v_cvt_pk_bf16_f32 v232, v170, v171
  v_cvt_pk_bf16_f32 v233, v172, v173
  s_waitcnt lgkmcnt(1)
  v_pk_fma_f32 v[24:25], v[102:103], v[126:127], v[24:25]
  v_pk_fma_f32 v[26:27], v[104:105], v[128:129], v[26:27]
  s_waitcnt lgkmcnt(0)
  v_pk_fma_f32 v[28:29], v[106:107], v[130:131], v[28:29]
  v_pk_fma_f32 v[30:31], v[108:109], v[132:133], v[30:31]
  v_cvt_pk_bf16_f32 v234, v24, v25
  v_cvt_pk_bf16_f32 v235, v26, v27
  v_cvt_pk_bf16_f32 v236, v28, v29
  v_cvt_pk_bf16_f32 v237, v30, v31
  v_lshlrev_b32 v24, 16, v234
  v_and_b32 v25, 0xffff0000, v234
  v_lshlrev_b32 v26, 16, v235
  v_and_b32 v27, 0xffff0000, v235
  v_lshlrev_b32 v28, 16, v236
  v_and_b32 v29, 0xffff0000, v236
  v_lshlrev_b32 v30, 16, v237
  v_and_b32 v31, 0xffff0000, v237
  v_pk_mul_f32 v[174:175], v[24:25], v[158:159]
  v_pk_mul_f32 v[176:177], v[26:27], v[160:161]
  v_pk_mul_f32 v[178:179], v[28:29], v[162:163]
  v_pk_mul_f32 v[180:181], v[30:31], v[164:165]
  v_cvt_pk_bf16_f32 v234, v174, v175
  v_cvt_pk_bf16_f32 v235, v176, v177
  v_cvt_pk_bf16_f32 v236, v178, v179
  v_cvt_pk_bf16_f32 v237, v180, v181
  s_cmp_eq_u32 s96, 0
  s_cbranch_scc1 Lslow_55
  buffer_store_dwordx4 v[230:233], v14, s[84:87], s5 offen
  buffer_store_dwordx4 v[234:237], v14, s[84:87], s5 offen offset:512
Lse_56:
  buffer_load_dwordx4 a[36:39], v2, s[84:87], s34 offen offset:0 sc1
  buffer_load_dwordx4 a[40:43], v2, s[84:87], s33 offen offset:1024 sc1
  buffer_load_dwordx4 a[44:47], v2, s[84:87], s34 offen offset:1024 sc1
  buffer_load_dwordx4 a[48:51], v2, s[84:87], s33 offen offset:2048 sc1
  v_pk_add_f32 v[78:79], v[16:17], v[18:19]
  v_pk_mul_f32 v[80:81], v[16:17], v[16:17]
  v_pk_add_f32 v[82:83], v[166:167], v[168:169]
  v_pk_mul_f32 v[84:85], v[166:167], v[166:167]
  v_pk_mul_f32 v[86:87], v[166:167], v[150:151]
  v_pk_mul_f32 v[88:89], v[166:167], v[134:135]
  v_pk_fma_f32 v[80:81], v[18:19], v[18:19], v[80:81]
  v_pk_fma_f32 v[84:85], v[168:169], v[168:169], v[84:85]
  v_pk_fma_f32 v[86:87], v[168:169], v[152:153], v[86:87]
  v_pk_fma_f32 v[88:89], v[168:169], v[136:137], v[88:89]
  v_pk_add_f32 v[78:79], v[78:79], v[20:21]
  v_pk_fma_f32 v[80:81], v[20:21], v[20:21], v[80:81]
  v_pk_add_f32 v[82:83], v[82:83], v[170:171]
  v_pk_fma_f32 v[84:85], v[170:171], v[170:171], v[84:85]
  v_pk_fma_f32 v[86:87], v[170:171], v[154:155], v[86:87]
  v_pk_fma_f32 v[88:89], v[170:171], v[138:139], v[88:89]
  v_pk_add_f32 v[78:79], v[78:79], v[22:23]
  v_pk_fma_f32 v[80:81], v[22:23], v[22:23], v[80:81]
  v_pk_add_f32 v[82:83], v[82:83], v[172:173]
  v_pk_fma_f32 v[84:85], v[172:173], v[172:173], v[84:85]
  v_pk_fma_f32 v[86:87], v[172:173], v[156:157], v[86:87]
  v_pk_fma_f32 v[88:89], v[172:173], v[140:141], v[88:89]
  v_pk_add_f32 v[78:79], v[78:79], v[24:25]
  v_pk_fma_f32 v[80:81], v[24:25], v[24:25], v[80:81]
  v_pk_add_f32 v[82:83], v[82:83], v[174:175]
  v_pk_fma_f32 v[84:85], v[174:175], v[174:175], v[84:85]
  v_pk_fma_f32 v[86:87], v[174:175], v[158:159], v[86:87]
  v_pk_fma_f32 v[88:89], v[174:175], v[142:143], v[88:89]
  v_pk_add_f32 v[78:79], v[78:79], v[26:27]
  v_pk_fma_f32 v[80:81], v[26:27], v[26:27], v[80:81]
  v_pk_add_f32 v[82:83], v[82:83], v[176:177]
  v_pk_fma_f32 v[84:85], v[176:177], v[176:177], v[84:85]
  v_pk_fma_f32 v[86:87], v[176:177], v[160:161], v[86:87]
  v_pk_fma_f32 v[88:89], v[176:177], v[144:145], v[88:89]
  v_pk_add_f32 v[78:79], v[78:79], v[28:29]
  v_pk_fma_f32 v[80:81], v[28:29], v[28:29], v[80:81]
  v_pk_add_f32 v[82:83], v[82:83], v[178:179]
  v_pk_fma_f32 v[84:85], v[178:179], v[178:179], v[84:85]
  v_pk_fma_f32 v[86:87], v[178:179], v[162:163], v[86:87]
  v_pk_fma_f32 v[88:89], v[178:179], v[146:147], v[88:89]
  v_pk_add_f32 v[78:79], v[78:79], v[30:31]
  v_pk_fma_f32 v[80:81], v[30:31], v[30:31], v[80:81]
  v_pk_add_f32 v[82:83], v[82:83], v[180:181]
  v_pk_fma_f32 v[84:85], v[180:181], v[180:181], v[84:85]
  v_pk_fma_f32 v[86:87], v[180:181], v[164:165], v[86:87]
  v_pk_fma_f32 v[88:89], v[180:181], v[148:149], v[88:89]
  v_add_f32 v94, v78, v79
  v_add_f32 v98, v84, v85
  v_add_f32 v95, v80, v81
  v_add_f32 v99, v86, v87
  v_add_f32 v96, v82, v83
  v_add_f32 v100, v88, v89
  v_permlane32_swap_b32 v94, v98
  v_permlane32_swap_b32 v95, v99
  v_permlane32_swap_b32 v96, v100
  v_add_f32 v94, v94, v98
  v_add_f32 v95, v95, v99
  v_add_f32 v96, v96, v100
  v_mov_b32 v97, v3
  ds_write_b128 v254, v[94:97]
  s_waitcnt vmcnt(4)
  s_add_u32 s4, s38, 0x3000
  s_mov_b64 exec, 1
  s_cmp_eq_u32 s96, 0
  s_cbranch_scc1 Lslow_57
  buffer_store_dword v3, v4, s[84:87], s4 offen
Lse_58:
  s_mov_b64 exec, -1
  s_waitcnt lgkmcnt(0)
  s_barrier
  ds_read_b128 v[98:101], v255
  s_waitcnt lgkmcnt(0)
  v_add_f32 v94, v94, v98
  v_add_f32 v95, v95, v99
  v_add_f32 v96, v96, v100
  s_cmp_eq_u32 s9, 0
  s_cselect_b64 exec, -1, 0
  buffer_store_dwordx4 v[94:97], v2, s[84:87], s73 offen sc1
  s_mov_b64 exec, -1
  s_xor_b32 s98, s21, 1
  s_mul_i32 s7, s21, 0x1c000
  s_mul_i32 s4, s92, 0x7000
  s_add_u32 s7, s7, s4
  s_lshl_b32 s4, s9, 12
  s_add_u32 s7, s7, s4
  s_add_u32 s7, s7, 0xb00000
  s_mul_i32 s28, s98, 0x1c000
  s_mul_i32 s4, s92, 0x7000
  s_add_u32 s28, s28, s4
  s_lshl_b32 s4, s9, 12
  s_add_u32 s28, s28, s4
  s_add_u32 s28, s28, 0xb00000
  s_lshl_b32 s29, s21, 15
  s_mul_i32 s4, s92, 0x1c00
  s_add_u32 s29, s29, s4
  s_lshl_b32 s4, s9, 10
  s_add_u32 s29, s29, s4
  s_add_u32 s29, s29, 0x300000
  s_xor_b32 s30, s29, 32768
  s_mov_b32 s26, 49152
  s_cmp_ge_u32 s94, 14
  s_cbranch_scc1 Lidle_59
  s_mov_b32 s55, s90
  s_add_u32 s55, s55, 0x100000
  s_movk_i32 s3, 12288
  v_add_u32 v73, 65536, v73
  ds_read_b128 v[32:35], v74 offset:512
  ds_read_b64_tr_b16 v[36:37], v73 offset:0
  ds_read_b64_tr_b16 v[38:39], v73 offset:512
  ds_read_b128 v[58:61], v74 offset:544
  ds_read_b64_tr_b16 v[62:63], v73 offset:4096
  ds_read_b64_tr_b16 v[64:65], v73 offset:4608
  ds_read_b128 v[78:81], v74 offset:576
  ds_read_b64_tr_b16 v[82:83], v73 offset:8192
  ds_read_b64_tr_b16 v[84:85], v73 offset:8704
  ds_read_b128 v[86:89], v74 offset:608
  ds_read_b64_tr_b16 v[90:91], v73 offset:12288
  ds_read_b64_tr_b16 v[92:93], v73 offset:12800
  s_waitcnt lgkmcnt(9)
  v_mfma_f32_32x32x16_bf16 v[238:253], v[32:35], v[36:39], v[238:253]
  buffer_load_dwordx4 a[52:55], v2, s[84:87], s34 offen offset:2048 sc1
  ds_read_b128 v[32:35], v74 offset:640
  ds_read_b64_tr_b16 v[36:37], v73 offset:16384
  ds_read_b64_tr_b16 v[38:39], v73 offset:16896
  s_waitcnt lgkmcnt(9)
  v_mfma_f32_32x32x16_bf16 v[238:253], v[58:61], v[62:65], v[238:253]
  buffer_load_dwordx4 a[56:59], v2, s[84:87], s33 offen offset:3072 sc1
  s_add_u32 s33, s33, 8192
  ds_read_b128 v[58:61], v74 offset:672
  ds_read_b64_tr_b16 v[62:63], v73 offset:20480
  ds_read_b64_tr_b16 v[64:65], v73 offset:20992
  s_waitcnt lgkmcnt(9)
  v_mfma_f32_32x32x16_bf16 v[238:253], v[78:81], v[82:85], v[238:253]
  buffer_load_dwordx4 a[60:63], v2, s[84:87], s34 offen offset:3072 sc1
  s_add_u32 s34, s34, 8192
  ds_read_b128 v[78:81], v74 offset:704
  ds_read_b64_tr_b16 v[82:83], v73 offset:24576
  ds_read_b64_tr_b16 v[84:85], v73 offset:25088
  s_waitcnt lgkmcnt(9)
  v_mfma_f32_32x32x16_bf16 v[238:253], v[86:89], v[90:93], v[238:253]
  buffer_load_dwordx4 a[64:67], v2, s[84:87], s33 offen offset:0 sc1
  ds_read_b128 v[86:89], v74 offset:736
  ds_read_b64_tr_b16 v[90:91], v73 offset:28672
  ds_read_b64_tr_b16 v[92:93], v73 offset:29184
  s_waitcnt lgkmcnt(9)
  v_mfma_f32_32x32x16_bf16 v[238:253], v[32:35], v[36:39], v[238:253]
  buffer_load_dwordx4 a[68:71], v2, s[84:87], s34 offen offset:0 sc1
  ds_read_b128 v[32:35], v74 offset:768
  ds_read_b64_tr_b16 v[36:37], v73 offset:32768
  ds_read_b64_tr_b16 v[38:39], v73 offset:33280
  s_waitcnt lgkmcnt(9)
  v_mfma_f32_32x32x16_bf16 v[238:253], v[58:61], v[62:65], v[238:253]
  buffer_load_dwordx4 a[72:75], v2, s[84:87], s33 offen offset:1024 sc1
  buffer_load_dword v54, v55, s[84:87], s3 offen sc1
  ds_read_b128 v[58:61], v74 offset:800
  ds_read_b64_tr_b16 v[62:63], v73 offset:36864
  ds_read_b64_tr_b16 v[64:65], v73 offset:37376
  s_waitcnt lgkmcnt(9)
  v_mfma_f32_32x32x16_bf16 v[238:253], v[78:81], v[82:85], v[238:253]
  buffer_load_dwordx4 a[76:79], v2, s[84:87], s34 offen offset:1024 sc1
  ds_read_b128 v[78:81], v74 offset:832
  ds_read_b64_tr_b16 v[82:83], v73 offset:40960
  ds_read_b64_tr_b16 v[84:85], v73 offset:41472
  s_waitcnt lgkmcnt(9)
  v_mfma_f32_32x32x16_bf16 v[238:253], v[86:89], v[90:93], v[238:253]
  ds_read_b128 v[86:89], v74 offset:864
  ds_read_b64_tr_b16 v[90:91], v73 offset:45056
  ds_read_b64_tr_b16 v[92:93], v73 offset:45568
  s_waitcnt lgkmcnt(9)
  v_mfma_f32_32x32x16_bf16 v[238:253], v[32:35], v[36:39], v[238:253]
  ds_read_b128 v[32:35], v74 offset:896
  ds_read_b64_tr_b16 v[36:37], v73 offset:49152
  ds_read_b64_tr_b16 v[38:39], v73 offset:49664
  s_waitcnt lgkmcnt(9)
  v_mfma_f32_32x32x16_bf16 v[238:253], v[58:61], v[62:65], v[238:253]
  ds_read_b128 v[58:61], v74 offset:928
  ds_read_b64_tr_b16 v[62:63], v73 offset:53248
  ds_read_b64_tr_b16 v[64:65], v73 offset:53760
  s_waitcnt lgkmcnt(9)
  v_mfma_f32_32x32x16_bf16 v[238:253], v[78:81], v[82:85], v[238:253]
  s_waitcnt vmcnt(1)
  v_cmp_ne_u32 vcc, s95, v54
  s_nop 0
  s_cmp_lg_u64 vcc, 0
  s_cbranch_scc1 Lre_61
Lok_62:
  buffer_load_dwordx4 a[128:131], v2, s[84:87], s55 offen offset:0 sc1
  buffer_load_dwordx4 a[132:135], v2, s[84:87], s55 offen offset:1024 sc1
  buffer_load_dwordx4 a[136:139], v2, s[84:87], s55 offen offset:2048 sc1
  buffer_load_dwordx4 a[140:143], v2, s[84:87], s55 offen offset:3072 sc1
  s_add_u32 s55, s55, 4096
  ds_read_b128 v[78:81], v74 offset:960
  ds_read_b64_tr_b16 v[82:83], v73 offset:57344
  ds_read_b64_tr_b16 v[84:85], v73 offset:57856
  s_waitcnt lgkmcnt(9)
  v_mfma_f32_32x32x16_bf16 v[238:253], v[86:89], v[90:93], v[238:253]
  buffer_load_dwordx4 a[144:147], v2, s[84:87], s55 offen offset:0 sc1
  ds_read_b128 v[86:89], v74 offset:992
  ds_read_b64_tr_b16 v[90:91], v73 offset:61440
  ds_read_b64_tr_b16 v[92:93], v73 offset:61952
  s_waitcnt lgkmcnt(9)
  v_mfma_f32_32x32x16_bf16 v[238:253], v[32:35], v[36:39], v[238:253]
  buffer_load_dwordx4 a[148:151], v2, s[84:87], s55 offen offset:1024 sc1
  s_waitcnt lgkmcnt(6)
  v_mfma_f32_32x32x16_bf16 v[238:253], v[58:61], v[62:65], v[238:253]
  buffer_load_dwordx4 a[152:155], v2, s[84:87], s55 offen offset:2048 sc1
  s_waitcnt lgkmcnt(3)
  v_mfma_f32_32x32x16_bf16 v[238:253], v[78:81], v[82:85], v[238:253]
  buffer_load_dwordx4 a[156:159], v2, s[84:87], s55 offen offset:3072 sc1
  s_add_u32 s55, s55, 4096
  s_waitcnt lgkmcnt(0)
  v_mfma_f32_32x32x16_bf16 v[238:253], v[86:89], v[90:93], v[238:253]
  buffer_load_dwordx4 a[160:163], v2, s[84:87], s55 offen offset:0 sc1
  buffer_load_dwordx4 a[164:167], v2, s[84:87], s55 offen offset:1024 sc1
  ds_read_b64_tr_b16 v[76:77], v51 offset:0
  ds_read_b64_tr_b16 v[78:79], v51 offset:512
  ds_read_b64_tr_b16 v[80:81], v52 offset:0
  ds_read_b64_tr_b16 v[82:83], v52 offset:512
  ds_read_b64_tr_b16 v[84:85], v51 offset:2048
  ds_read_b64_tr_b16 v[86:87], v51 offset:2560
  ds_read_b64_tr_b16 v[88:89], v52 offset:2048
  ds_read_b64_tr_b16 v[90:91], v52 offset:2560
  ds_read_b64_tr_b16 v[92:93], v51 offset:4096
  ds_read_b64_tr_b16 v[94:95], v51 offset:4608
  ds_read_b64_tr_b16 v[96:97], v52 offset:4096
  ds_read_b64_tr_b16 v[98:99], v52 offset:4608
  ds_read_b64_tr_b16 v[100:101], v51 offset:6144
  ds_read_b64_tr_b16 v[102:103], v51 offset:6656
  ds_read_b64_tr_b16 v[104:105], v52 offset:6144
  ds_read_b64_tr_b16 v[106:107], v52 offset:6656
  s_lshr_b32 s98, s90, 2
  s_mov_b32 s5, s98
  s_add_u32 s5, s5, 0x80000
  s_mov_b32 s11, s98
  s_add_u32 s11, s11, 0x81000
  v_cvt_pk_bf16_f32 v32, v238, v238
  v_cvt_pk_bf16_f32 v10, 0, v239
  v_and_b32 v9, 0xffff0000, v32
  v_sub_f32 v9, v238, v9
  v_sub_f32 v8, v239, v10
  v_cvt_pk_bf16_f32 v33, v9, v10
  v_cvt_pk_bf16_f32 v34, v10, v8
  v_lshl_or_b32 v35, v70, 16, v70
  v_add_u32 v15, 147456, v2
  s_lshl_b32 s98, s92, 10
  v_add_u32 v9, s98, v15
  ds_write_b128 v9, v[32:35]
  s_waitcnt vmcnt(9) lgkmcnt(9)
  v_mfma_f32_32x32x16_bf16 v[156:171], v[76:79], a[128:131], 0
  ds_read_b64_tr_b16 v[108:109], v51 offset:8192
  ds_read_b64_tr_b16 v[110:111], v51 offset:8704
  buffer_load_dwordx4 a[168:171], v2, s[84:87], s55 offen offset:2048 sc1
  v_mfma_f32_32x32x16_bf16 v[172:187], v[80:83], a[128:131], 0
  ds_read_b64_tr_b16 v[112:113], v52 offset:8192
  ds_read_b64_tr_b16 v[114:115], v52 offset:8704
  v_mfma_f32_32x32x16_bf16 v[188:203], v[84:87], a[128:131], 0
  ds_read_b64_tr_b16 v[116:117], v51 offset:10240
  ds_read_b64_tr_b16 v[118:119], v51 offset:10752
  buffer_load_dwordx4 a[172:175], v2, s[84:87], s55 offen offset:3072 sc1
  s_add_u32 s55, s55, 4096
  v_mfma_f32_32x32x16_bf16 v[204:219], v[88:91], a[128:131], 0
  ds_read_b64_tr_b16 v[120:121], v52 offset:10240
  ds_read_b64_tr_b16 v[122:123], v52 offset:10752
  s_waitcnt vmcnt(10) lgkmcnt(9)
  v_mfma_f32_32x32x16_bf16 v[156:171], v[92:95], a[132:135], v[156:171]
  ds_read_b64_tr_b16 v[76:77], v51 offset:12288
  ds_read_b64_tr_b16 v[78:79], v51 offset:12800
  buffer_load_dwordx4 a[176:179], v2, s[84:87], s55 offen offset:0 sc1
  v_mfma_f32_32x32x16_bf16 v[172:187], v[96:99], a[132:135], v[172:187]
  ds_read_b64_tr_b16 v[80:81], v52 offset:12288
  ds_read_b64_tr_b16 v[82:83], v52 offset:12800
  v_mfma_f32_32x32x16_bf16 v[188:203], v[100:103], a[132:135], v[188:203]
  ds_read_b64_tr_b16 v[84:85], v51 offset:14336
  ds_read_b64_tr_b16 v[86:87], v51 offset:14848
  buffer_load_dwordx4 a[180:183], v2, s[84:87], s55 offen offset:1024 sc1
  v_mfma_f32_32x32x16_bf16 v[204:219], v[104:107], a[132:135], v[204:219]
  ds_read_b64_tr_b16 v[88:89], v52 offset:14336
  ds_read_b64_tr_b16 v[90:91], v52 offset:14848
  s_waitcnt vmcnt(11) lgkmcnt(8)
  v_mfma_f32_32x32x16_bf16 v[156:171], v[108:111], a[136:139], v[156:171]
  ds_read_b64_tr_b16 v[92:93], v51 offset:16384
  ds_read_b64_tr_b16 v[94:95], v51 offset:16896
  buffer_load_dwordx4 a[184:187], v2, s[84:87], s55 offen offset:2048 sc1
  v_mfma_f32_32x32x16_bf16 v[172:187], v[112:115], a[136:139], v[172:187]
  ds_read_b64_tr_b16 v[96:97], v52 offset:16384
  ds_read_b64_tr_b16 v[98:99], v52 offset:16896
  v_mfma_f32_32x32x16_bf16 v[188:203], v[116:119], a[136:139], v[188:203]
  ds_read_b64_tr_b16 v[100:101], v51 offset:18432
  ds_read_b64_tr_b16 v[102:103], v51 offset:18944
  buffer_load_dwordx4 a[188:191], v2, s[84:87], s55 offen offset:3072 sc1
  s_add_u32 s55, s55, 4096
  v_mfma_f32_32x32x16_bf16 v[204:219], v[120:123], a[136:139], v[204:219]
  ds_read_b64_tr_b16 v[104:105], v52 offset:18432
  ds_read_b64_tr_b16 v[106:107], v52 offset:18944
  s_waitcnt vmcnt(12) lgkmcnt(8)
  v_mfma_f32_32x32x16_bf16 v[156:171], v[76:79], a[140:143], v[156:171]
  ds_read_b64_tr_b16 v[108:109], v51 offset:20480
  ds_read_b64_tr_b16 v[110:111], v51 offset:20992
  buffer_load_dwordx4 a[192:195], v2, s[84:87], s55 offen offset:0 sc1
  v_mfma_f32_32x32x16_bf16 v[172:187], v[80:83], a[140:143], v[172:187]
  ds_read_b64_tr_b16 v[112:113], v52 offset:20480
  ds_read_b64_tr_b16 v[114:115], v52 offset:20992
  v_mfma_f32_32x32x16_bf16 v[188:203], v[84:87], a[140:143], v[188:203]
  ds_read_b64_tr_b16 v[116:117], v51 offset:22528
  ds_read_b64_tr_b16 v[118:119], v51 offset:23040
  buffer_load_dwordx4 a[196:199], v2, s[84:87], s55 offen offset:1024 sc1
  v_mfma_f32_32x32x16_bf16 v[204:219], v[88:91], a[140:143], v[204:219]
  ds_read_b64_tr_b16 v[120:121], v52 offset:22528
  ds_read_b64_tr_b16 v[122:123], v52 offset:23040
  s_waitcnt vmcnt(13) lgkmcnt(8)
  v_mfma_f32_32x32x16_bf16 v[156:171], v[92:95], a[144:147], v[156:171]
  ds_read_b64_tr_b16 v[76:77], v51 offset:24576
  ds_read_b64_tr_b16 v[78:79], v51 offset:25088
  buffer_load_dwordx4 a[200:203], v2, s[84:87], s55 offen offset:2048 sc1
  v_mfma_f32_32x32x16_bf16 v[172:187], v[96:99], a[144:147], v[172:187]
  ds_read_b64_tr_b16 v[80:81], v52 offset:24576
  ds_read_b64_tr_b16 v[82:83], v52 offset:25088
  v_mfma_f32_32x32x16_bf16 v[188:203], v[100:103], a[144:147], v[188:203]
  ds_read_b64_tr_b16 v[84:85], v51 offset:26624
  ds_read_b64_tr_b16 v[86:87], v51 offset:27136
  buffer_load_dwordx4 a[204:207], v2, s[84:87], s55 offen offset:3072 sc1
  s_add_u32 s55, s55, 4096
  v_mfma_f32_32x32x16_bf16 v[204:219], v[104:107], a[144:147], v[204:219]
  ds_read_b64_tr_b16 v[88:89], v52 offset:26624
  ds_read_b64_tr_b16 v[90:91], v52 offset:27136
  s_waitcnt vmcnt(14) lgkmcnt(8)
  v_mfma_f32_32x32x16_bf16 v[156:171], v[108:111], a[148:151], v[156:171]
  ds_read_b64_tr_b16 v[92:93], v51 offset:28672
  ds_read_b64_tr_b16 v[94:95], v51 offset:29184
  buffer_load_dwordx4 a[208:211], v2, s[84:87], s55 offen offset:0 sc1
  v_mfma_f32_32x32x16_bf16 v[172:187], v[112:115], a[148:151], v[172:187]
  ds_read_b64_tr_b16 v[96:97], v52 offset:28672
  ds_read_b64_tr_b16 v[98:99], v52 offset:29184
  v_mfma_f32_32x32x16_bf16 v[188:203], v[116:119], a[148:151], v[188:203]
  ds_read_b64_tr_b16 v[100:101], v51 offset:30720
  ds_read_b64_tr_b16 v[102:103], v51 offset:31232
  buffer_load_dwordx4 a[212:215], v2, s[84:87], s55 offen offset:1024 sc1
  v_mfma_f32_32x32x16_bf16 v[204:219], v[120:123], a[148:151], v[204:219]
  ds_read_b64_tr_b16 v[104:105], v52 offset:30720
  ds_read_b64_tr_b16 v[106:107], v52 offset:31232
  s_waitcnt vmcnt(15) lgkmcnt(8)
  v_mfma_f32_32x32x16_bf16 v[156:171], v[76:79], a[152:155], v[156:171]
  ds_read_b64_tr_b16 v[108:109], v51 offset:32768
  ds_read_b64_tr_b16 v[110:111], v51 offset:33280
  buffer_load_dwordx4 a[216:219], v2, s[84:87], s55 offen offset:2048 sc1
  v_mfma_f32_32x32x16_bf16 v[172:187], v[80:83], a[152:155], v[172:187]
  ds_read_b64_tr_b16 v[112:113], v52 offset:32768
  ds_read_b64_tr_b16 v[114:115], v52 offset:33280
  v_mfma_f32_32x32x16_bf16 v[188:203], v[84:87], a[152:155], v[188:203]
  ds_read_b64_tr_b16 v[116:117], v51 offset:34816
  ds_read_b64_tr_b16 v[118:119], v51 offset:35328
  buffer_load_dwordx4 a[220:223], v2, s[84:87], s55 offen offset:3072 sc1
  s_add_u32 s55, s55, 4096
  v_mfma_f32_32x32x16_bf16 v[204:219], v[88:91], a[152:155], v[204:219]
  ds_read_b64_tr_b16 v[120:121], v52 offset:34816
  ds_read_b64_tr_b16 v[122:123], v52 offset:35328
  s_barrier
  s_waitcnt vmcnt(16) lgkmcnt(8)
  v_mfma_f32_32x32x16_bf16 v[156:171], v[92:95], a[156:159], v[156:171]
  ds_read_b64_tr_b16 v[76:77], v51 offset:36864
  ds_read_b64_tr_b16 v[78:79], v51 offset:37376
  buffer_load_dwordx4 a[224:227], v2, s[84:87], s55 offen offset:0 sc1
  v_mfma_f32_32x32x16_bf16 v[172:187], v[96:99], a[156:159], v[172:187]
  ds_read_b64_tr_b16 v[80:81], v52 offset:36864
  ds_read_b64_tr_b16 v[82:83], v52 offset:37376
  v_mfma_f32_32x32x16_bf16 v[188:203], v[100:103], a[156:159], v[188:203]
  ds_read_b64_tr_b16 v[84:85], v51 offset:38912
  ds_read_b64_tr_b16 v[86:87], v51 offset:39424
  buffer_load_dwordx4 a[228:231], v2, s[84:87], s55 offen offset:1024 sc1
  v_mfma_f32_32x32x16_bf16 v[204:219], v[104:107], a[156:159], v[204:219]
  ds_read_b64_tr_b16 v[88:89], v52 offset:38912
  ds_read_b64_tr_b16 v[90:91], v52 offset:39424
  s_waitcnt vmcnt(17) lgkmcnt(8)
  v_mfma_f32_32x32x16_bf16 v[156:171], v[108:111], a[160:163], v[156:171]
  ds_read_b64_tr_b16 v[92:93], v51 offset:40960
  ds_read_b64_tr_b16 v[94:95], v51 offset:41472
  buffer_load_dwordx4 a[232:235], v2, s[84:87], s55 offen offset:2048 sc1
  v_mfma_f32_32x32x16_bf16 v[172:187], v[112:115], a[160:163], v[172:187]
  ds_read_b64_tr_b16 v[96:97], v52 offset:40960
  ds_read_b64_tr_b16 v[98:99], v52 offset:41472
  v_mfma_f32_32x32x16_bf16 v[188:203], v[116:119], a[160:163], v[188:203]
  ds_read_b64_tr_b16 v[100:101], v51 offset:43008
  ds_read_b64_tr_b16 v[102:103], v51 offset:43520
  buffer_load_dwordx4 a[236:239], v2, s[84:87], s55 offen offset:3072 sc1
  s_add_u32 s55, s55, 4096
  v_mfma_f32_32x32x16_bf16 v[204:219], v[120:123], a[160:163], v[204:219]
  ds_read_b64_tr_b16 v[104:105], v52 offset:43008
  ds_read_b64_tr_b16 v[106:107], v52 offset:43520
  s_waitcnt vmcnt(18) lgkmcnt(8)
  v_mfma_f32_32x32x16_bf16 v[156:171], v[76:79], a[164:167], v[156:171]
  ds_read_b64_tr_b16 v[108:109], v51 offset:45056
  ds_read_b64_tr_b16 v[110:111], v51 offset:45568
  buffer_load_dwordx4 a[240:243], v2, s[84:87], s55 offen offset:0 sc1
  v_mfma_f32_32x32x16_bf16 v[172:187], v[80:83], a[164:167], v[172:187]
  ds_read_b64_tr_b16 v[112:113], v52 offset:45056
  ds_read_b64_tr_b16 v[114:115], v52 offset:45568
  v_mfma_f32_32x32x16_bf16 v[188:203], v[84:87], a[164:167], v[188:203]
  ds_read_b64_tr_b16 v[116:117], v51 offset:47104
  ds_read_b64_tr_b16 v[118:119], v51 offset:47616
  buffer_load_dwordx4 a[244:247], v2, s[84:87], s55 offen offset:1024 sc1
  v_mfma_f32_32x32x16_bf16 v[204:219], v[88:91], a[164:167], v[204:219]
  ds_read_b64_tr_b16 v[120:121], v52 offset:47104
  ds_read_b64_tr_b16 v[122:123], v52 offset:47616
  s_waitcnt vmcnt(19) lgkmcnt(8)
  v_mfma_f32_32x32x16_bf16 v[156:171], v[92:95], a[168:171], v[156:171]
  ds_read_b64_tr_b16 v[76:77], v51 offset:49152
  ds_read_b64_tr_b16 v[78:79], v51 offset:49664
  buffer_load_dwordx4 a[248:251], v2, s[84:87], s55 offen offset:2048 sc1
  v_mfma_f32_32x32x16_bf16 v[172:187], v[96:99], a[168:171], v[172:187]
  ds_read_b64_tr_b16 v[80:81], v52 offset:49152
  ds_read_b64_tr_b16 v[82:83], v52 offset:49664
  v_mfma_f32_32x32x16_bf16 v[188:203], v[100:103], a[168:171], v[188:203]
  ds_read_b64_tr_b16 v[84:85], v51 offset:51200
  ds_read_b64_tr_b16 v[86:87], v51 offset:51712
  buffer_load_dwordx4 a[252:255], v2, s[84:87], s55 offen offset:3072 sc1
  s_add_u32 s55, s55, 4096
  v_mfma_f32_32x32x16_bf16 v[204:219], v[104:107], a[168:171], v[204:219]
  ds_read_b64_tr_b16 v[88:89], v52 offset:51200
  ds_read_b64_tr_b16 v[90:91], v52 offset:51712
  s_waitcnt vmcnt(20) lgkmcnt(8)
  v_mfma_f32_32x32x16_bf16 v[156:171], v[108:111], a[172:175], v[156:171]
  ds_read_b64_tr_b16 v[92:93], v51 offset:53248
  ds_read_b64_tr_b16 v[94:95], v51 offset:53760
  buffer_load_dwordx4 v[124:127], v2, s[84:87], s5 offen offset:0 sc1
  v_mfma_f32_32x32x16_bf16 v[172:187], v[112:115], a[172:175], v[172:187]
  ds_read_b64_tr_b16 v[96:97], v52 offset:53248
  ds_read_b64_tr_b16 v[98:99], v52 offset:53760
  v_mfma_f32_32x32x16_bf16 v[188:203], v[116:119], a[172:175], v[188:203]
  ds_read_b64_tr_b16 v[100:101], v51 offset:55296
  ds_read_b64_tr_b16 v[102:103], v51 offset:55808
  buffer_load_dwordx4 v[128:131], v2, s[84:87], s5 offen offset:1024 sc1
  v_mfma_f32_32x32x16_bf16 v[204:219], v[120:123], a[172:175], v[204:219]
  ds_read_b64_tr_b16 v[104:105], v52 offset:55296
  ds_read_b64_tr_b16 v[106:107], v52 offset:55808
  s_waitcnt vmcnt(21) lgkmcnt(8)
  v_mfma_f32_32x32x16_bf16 v[156:171], v[76:79], a[176:179], v[156:171]
  ds_read_b64_tr_b16 v[108:109], v51 offset:57344
  ds_read_b64_tr_b16 v[110:111], v51 offset:57856
  buffer_load_dwordx4 v[132:135], v2, s[84:87], s5 offen offset:2048 sc1
  v_mfma_f32_32x32x16_bf16 v[172:187], v[80:83], a[176:179], v[172:187]
  ds_read_b64_tr_b16 v[112:113], v52 offset:57344
  ds_read_b64_tr_b16 v[114:115], v52 offset:57856
  v_mfma_f32_32x32x16_bf16 v[188:203], v[84:87], a[176:179], v[188:203]
  ds_read_b64_tr_b16 v[116:117], v51 offset:59392
  ds_read_b64_tr_b16 v[118:119], v51 offset:59904
  buffer_load_dwordx4 v[136:139], v2, s[84:87], s5 offen offset:3072 sc1
  v_mfma_f32_32x32x16_bf16 v[204:219], v[88:91], a[176:179], v[204:219]
  ds_read_b64_tr_b16 v[120:121], v52 offset:59392
  ds_read_b64_tr_b16 v[122:123], v52 offset:59904
  s_waitcnt vmcnt(22) lgkmcnt(8)
  v_mfma_f32_32x32x16_bf16 v[156:171], v[92:95], a[180:183], v[156:171]
  ds_read_b64_tr_b16 v[76:77], v51 offset:61440
  ds_read_b64_tr_b16 v[78:79], v51 offset:61952
  buffer_load_dwordx4 v[140:143], v2, s[84:87], s11 offen offset:0 sc1
  v_mfma_f32_32x32x16_bf16 v[172:187], v[96:99], a[180:183], v[172:187]
  ds_read_b64_tr_b16 v[80:81], v52 offset:61440
  ds_read_b64_tr_b16 v[82:83], v52 offset:61952
  v_mfma_f32_32x32x16_bf16 v[188:203], v[100:103], a[180:183], v[188:203]
  ds_read_b64_tr_b16 v[84:85], v51 offset:63488
  ds_read_b64_tr_b16 v[86:87], v51 offset:64000
  buffer_load_dwordx4 v[144:147], v2, s[84:87], s11 offen offset:1024 sc1
  v_mfma_f32_32x32x16_bf16 v[204:219], v[104:107], a[180:183], v[204:219]
  ds_read_b64_tr_b16 v[88:89], v52 offset:63488
  ds_read_b64_tr_b16 v[90:91], v52 offset:64000
  s_waitcnt vmcnt(23) lgkmcnt(8)
  v_mfma_f32_32x32x16_bf16 v[156:171], v[108:111], a[184:187], v[156:171]
  ds_read_b64_tr_b16 v[92:93], v71 offset:0
  ds_read_b64_tr_b16 v[94:95], v71 offset:512
  buffer_load_dwordx4 v[148:151], v2, s[84:87], s11 offen offset:2048 sc1
  v_mfma_f32_32x32x16_bf16 v[172:187], v[112:115], a[184:187], v[172:187]
  ds_read_b64_tr_b16 v[96:97], v72 offset:0
  ds_read_b64_tr_b16 v[98:99], v72 offset:512
  v_mfma_f32_32x32x16_bf16 v[188:203], v[116:119], a[184:187], v[188:203]
  ds_read_b64_tr_b16 v[100:101], v71 offset:2048
  ds_read_b64_tr_b16 v[102:103], v71 offset:2560
  buffer_load_dwordx4 v[152:155], v2, s[84:87], s11 offen offset:3072 sc1
  v_mfma_f32_32x32x16_bf16 v[204:219], v[120:123], a[184:187], v[204:219]
  ds_read_b64_tr_b16 v[104:105], v72 offset:2048
  ds_read_b64_tr_b16 v[106:107], v72 offset:2560
  s_waitcnt vmcnt(24) lgkmcnt(8)
  v_mfma_f32_32x32x16_bf16 v[156:171], v[76:79], a[188:191], v[156:171]
  ds_read_b64_tr_b16 v[108:109], v71 offset:4096
  ds_read_b64_tr_b16 v[110:111], v71 offset:4608
  buffer_load_dwordx4 a[80:83], v2, s[84:87], s33 offen offset:2048 sc1
  v_mfma_f32_32x32x16_bf16 v[172:187], v[80:83], a[188:191], v[172:187]
  ds_read_b64_tr_b16 v[112:113], v72 offset:4096
  ds_read_b64_tr_b16 v[114:115], v72 offset:4608
  v_mfma_f32_32x32x16_bf16 v[188:203], v[84:87], a[188:191], v[188:203]
  ds_read_b64_tr_b16 v[116:117], v71 offset:6144
  ds_read_b64_tr_b16 v[118:119], v71 offset:6656
  buffer_load_dwordx4 a[84:87], v2, s[84:87], s34 offen offset:2048 sc1
  v_mfma_f32_32x32x16_bf16 v[204:219], v[88:91], a[188:191], v[204:219]
  ds_read_b64_tr_b16 v[120:121], v72 offset:6144
  ds_read_b64_tr_b16 v[122:123], v72 offset:6656
  s_waitcnt vmcnt(25) lgkmcnt(8)
  v_mfma_f32_32x32x16_bf16 v[156:171], v[92:95], a[192:195], v[156:171]
  ds_read_b64_tr_b16 v[76:77], v71 offset:8192
  ds_read_b64_tr_b16 v[78:79], v71 offset:8704
  buffer_load_dwordx4 a[88:91], v2, s[84:87], s33 offen offset:3072 sc1
  s_add_u32 s33, s33, s35
  v_mfma_f32_32x32x16_bf16 v[172:187], v[96:99], a[192:195], v[172:187]
  ds_read_b64_tr_b16 v[80:81], v72 offset:8192
  ds_read_b64_tr_b16 v[82:83], v72 offset:8704
  v_mfma_f32_32x32x16_bf16 v[188:203], v[100:103], a[192:195], v[188:203]
  ds_read_b64_tr_b16 v[84:85], v71 offset:10240
  ds_read_b64_tr_b16 v[86:87], v71 offset:10752
  buffer_load_dwordx4 a[92:95], v2, s[84:87], s34 offen offset:3072 sc1
  s_add_u32 s34, s34, s35
  v_mfma_f32_32x32x16_bf16 v[204:219], v[104:107], a[192:195], v[204:219]
  ds_read_b64_tr_b16 v[88:89], v72 offset:10240
  ds_read_b64_tr_b16 v[90:91], v72 offset:10752
  s_waitcnt vmcnt(26) lgkmcnt(8)
  v_mfma_f32_32x32x16_bf16 v[156:171], v[108:111], a[196:199], v[156:171]
  ds_read_b64_tr_b16 v[92:93], v71 offset:12288
  ds_read_b64_tr_b16 v[94:95], v71 offset:12800
  buffer_load_dwordx4 a[96:99], v2, s[84:87], s33 offen offset:0 sc1
  v_mfma_f32_32x32x16_bf16 v[172:187], v[112:115], a[196:199], v[172:187]
  ds_read_b64_tr_b16 v[96:97], v72 offset:12288
  ds_read_b64_tr_b16 v[98:99], v72 offset:12800
  v_mfma_f32_32x32x16_bf16 v[188:203], v[116:119], a[196:199], v[188:203]
  ds_read_b64_tr_b16 v[100:101], v71 offset:14336
  ds_read_b64_tr_b16 v[102:103], v71 offset:14848
  buffer_load_dwordx4 a[100:103], v2, s[84:87], s34 offen offset:0 sc1
  v_mfma_f32_32x32x16_bf16 v[204:219], v[120:123], a[196:199], v[204:219]
  ds_read_b64_tr_b16 v[104:105], v72 offset:14336
  ds_read_b64_tr_b16 v[106:107], v72 offset:14848
  s_waitcnt vmcnt(27) lgkmcnt(8)
  v_mfma_f32_32x32x16_bf16 v[156:171], v[76:79], a[200:203], v[156:171]
  ds_read_b64_tr_b16 v[108:109], v71 offset:16384
  ds_read_b64_tr_b16 v[110:111], v71 offset:16896
  buffer_load_dwordx4 a[104:107], v2, s[84:87], s33 offen offset:1024 sc1
  v_mfma_f32_32x32x16_bf16 v[172:187], v[80:83], a[200:203], v[172:187]
  ds_read_b64_tr_b16 v[112:113], v72 offset:16384
  ds_read_b64_tr_b16 v[114:115], v72 offset:16896
  v_mfma_f32_32x32x16_bf16 v[188:203], v[84:87], a[200:203], v[188:203]
  ds_read_b64_tr_b16 v[116:117], v71 offset:18432
  ds_read_b64_tr_b16 v[118:119], v71 offset:18944
  buffer_load_dwordx4 a[108:111], v2, s[84:87], s34 offen offset:1024 sc1
  v_mfma_f32_32x32x16_bf16 v[204:219], v[88:91], a[200:203], v[204:219]
  ds_read_b64_tr_b16 v[120:121], v72 offset:18432
  ds_read_b64_tr_b16 v[122:123], v72 offset:18944
  s_waitcnt vmcnt(28) lgkmcnt(8)
  v_mfma_f32_32x32x16_bf16 v[156:171], v[92:95], a[204:207], v[156:171]
  ds_read_b64_tr_b16 v[76:77], v71 offset:20480
  ds_read_b64_tr_b16 v[78:79], v71 offset:20992
  buffer_load_dwordx4 a[112:115], v2, s[84:87], s33 offen offset:2048 sc1
  v_mfma_f32_32x32x16_bf16 v[172:187], v[96:99], a[204:207], v[172:187]
  ds_read_b64_tr_b16 v[80:81], v72 offset:20480
  ds_read_b64_tr_b16 v[82:83], v72 offset:20992
  v_mfma_f32_32x32x16_bf16 v[188:203], v[100:103], a[204:207], v[188:203]
  ds_read_b64_tr_b16 v[84:85], v71 offset:22528
  ds_read_b64_tr_b16 v[86:87], v71 offset:23040
  buffer_load_dwordx4 a[116:119], v2, s[84:87], s34 offen offset:2048 sc1
  v_mfma_f32_32x32x16_bf16 v[204:219], v[104:107], a[204:207], v[204:219]
  ds_read_b64_tr_b16 v[88:89], v72 offset:22528
  ds_read_b64_tr_b16 v[90:91], v72 offset:23040
  s_waitcnt vmcnt(29) lgkmcnt(8)
  v_mfma_f32_32x32x16_bf16 v[156:171], v[108:111], a[208:211], v[156:171]
  ds_read_b64_tr_b16 v[92:93], v71 offset:24576
  ds_read_b64_tr_b16 v[94:95], v71 offset:25088
  buffer_load_dwordx4 a[120:123], v2, s[84:87], s33 offen offset:3072 sc1
  s_add_u32 s33, s33, s36
  v_mfma_f32_32x32x16_bf16 v[172:187], v[112:115], a[208:211], v[172:187]
  ds_read_b64_tr_b16 v[96:97], v72 offset:24576
  ds_read_b64_tr_b16 v[98:99], v72 offset:25088
  v_mfma_f32_32x32x16_bf16 v[188:203], v[116:119], a[208:211], v[188:203]
  ds_read_b64_tr_b16 v[100:101], v71 offset:26624
  ds_read_b64_tr_b16 v[102:103], v71 offset:27136
  buffer_load_dwordx4 a[124:127], v2, s[84:87], s34 offen offset:3072 sc1
  s_add_u32 s34, s34, s36
  v_mfma_f32_32x32x16_bf16 v[204:219], v[120:123], a[208:211], v[204:219]
  ds_read_b64_tr_b16 v[104:105], v72 offset:26624
  ds_read_b64_tr_b16 v[106:107], v72 offset:27136
  s_waitcnt vmcnt(30) lgkmcnt(8)
  v_mfma_f32_32x32x16_bf16 v[156:171], v[76:79], a[212:215], v[156:171]
  ds_read_b64_tr_b16 v[108:109], v71 offset:28672
  ds_read_b64_tr_b16 v[110:111], v71 offset:29184
  buffer_load_dwordx4 a[128:131], v2, s[84:87], s33 offen offset:0 sc1
  v_mfma_f32_32x32x16_bf16 v[172:187], v[80:83], a[212:215], v[172:187]
  ds_read_b64_tr_b16 v[112:113], v72 offset:28672
  ds_read_b64_tr_b16 v[114:115], v72 offset:29184
  v_mfma_f32_32x32x16_bf16 v[188:203], v[84:87], a[212:215], v[188:203]
  ds_read_b64_tr_b16 v[116:117], v71 offset:30720
  ds_read_b64_tr_b16 v[118:119], v71 offset:31232
  buffer_load_dwordx4 a[132:135], v2, s[84:87], s34 offen offset:0 sc1
  v_mfma_f32_32x32x16_bf16 v[204:219], v[88:91], a[212:215], v[204:219]
  ds_read_b64_tr_b16 v[120:121], v72 offset:30720
  ds_read_b64_tr_b16 v[122:123], v72 offset:31232
  s_waitcnt vmcnt(21)
  v_xor_b32 v127, v3, v127
  s_waitcnt vmcnt(20)
  v_bitop3_b32 v127, v127, v131, v3 bitop3:0xf6
  s_waitcnt vmcnt(19)
  v_bitop3_b32 v127, v127, v135, v3 bitop3:0xf6
  s_waitcnt vmcnt(18)
  v_bitop3_b32 v127, v127, v139, v3 bitop3:0xf6
  s_waitcnt vmcnt(17)
  v_bitop3_b32 v127, v127, v143, v3 bitop3:0xf6
  s_waitcnt vmcnt(16)
  v_bitop3_b32 v127, v127, v147, v3 bitop3:0xf6
  s_waitcnt vmcnt(15)
  v_bitop3_b32 v127, v127, v151, v3 bitop3:0xf6
  s_waitcnt vmcnt(14)
  v_bitop3_b32 v127, v127, v155, v3 bitop3:0xf6
  v_cmp_ne_u32 vcc, 0, v127
  s_nop 0
  s_cmp_lg_u64 vcc, 0
  s_cbranch_scc1 Lre_64
Lok_65:
  s_waitcnt lgkmcnt(8)
  v_mfma_f32_32x32x16_bf16 v[156:171], v[92:95], a[216:219], v[156:171]
  ds_read_b64_tr_b16 v[76:77], v71 offset:32768
  ds_read_b64_tr_b16 v[78:79], v71 offset:33280
  buffer_load_dwordx4 a[136:139], v2, s[84:87], s33 offen offset:1024 sc1
  v_mfma_f32_32x32x16_bf16 v[172:187], v[96:99], a[216:219], v[172:187]
  ds_read_b64_tr_b16 v[80:81], v72 offset:32768
  ds_read_b64_tr_b16 v[82:83], v72 offset:33280
  v_add_f32 v124, v124, v128
  v_add_f32 v125, v125, v129
  v_add_f32 v126, v126, v130
  v_mfma_f32_32x32x16_bf16 v[188:203], v[100:103], a[216:219], v[188:203]
  ds_read_b64_tr_b16 v[84:85], v71 offset:34816
  ds_read_b64_tr_b16 v[86:87], v71 offset:35328
  buffer_load_dwordx4 a[140:143], v2, s[84:87], s34 offen offset:1024 sc1
  v_mfma_f32_32x32x16_bf16 v[204:219], v[104:107], a[216:219], v[204:219]
  ds_read_b64_tr_b16 v[88:89], v72 offset:34816
  ds_read_b64_tr_b16 v[90:91], v72 offset:35328
  v_add_f32 v124, v124, v132
  v_add_f32 v125, v125, v133
  v_add_f32 v126, v126, v134
  s_waitcnt lgkmcnt(8)
  v_mfma_f32_32x32x16_bf16 v[156:171], v[108:111], a[220:223], v[156:171]
  ds_read_b64_tr_b16 v[92:93], v71 offset:36864
  ds_read_b64_tr_b16 v[94:95], v71 offset:37376
  buffer_load_dwordx4 a[144:147], v2, s[84:87], s33 offen offset:2048 sc1
  v_mfma_f32_32x32x16_bf16 v[172:187], v[112:115], a[220:223], v[172:187]
  ds_read_b64_tr_b16 v[96:97], v72 offset:36864
  ds_read_b64_tr_b16 v[98:99], v72 offset:37376
  v_add_f32 v124, v124, v136
  v_add_f32 v125, v125, v137
  v_add_f32 v126, v126, v138
  v_mfma_f32_32x32x16_bf16 v[188:203], v[116:119], a[220:223], v[188:203]
  ds_read_b64_tr_b16 v[100:101], v71 offset:38912
  ds_read_b64_tr_b16 v[102:103], v71 offset:39424
  buffer_load_dwordx4 a[148:151], v2, s[84:87], s34 offen offset:2048 sc1
  v_mfma_f32_32x32x16_bf16 v[204:219], v[120:123], a[220:223], v[204:219]
  ds_read_b64_tr_b16 v[104:105], v72 offset:38912
  ds_read_b64_tr_b16 v[106:107], v72 offset:39424
  v_add_f32 v124, v124, v140
  v_add_f32 v125, v125, v141
  v_add_f32 v126, v126, v142
  s_waitcnt lgkmcnt(8)
  v_mfma_f32_32x32x16_bf16 v[156:171], v[76:79], a[224:227], v[156:171]
  ds_read_b64_tr_b16 v[108:109], v71 offset:40960
  ds_read_b64_tr_b16 v[110:111], v71 offset:41472
  buffer_load_dwordx4 a[152:155], v2, s[84:87], s33 offen offset:3072 sc1
  s_add_u32 s33, s33, 8192
  v_mfma_f32_32x32x16_bf16 v[172:187], v[80:83], a[224:227], v[172:187]
  ds_read_b64_tr_b16 v[112:113], v72 offset:40960
  ds_read_b64_tr_b16 v[114:115], v72 offset:41472
  v_add_f32 v124, v124, v144
  v_add_f32 v125, v125, v145
  v_add_f32 v126, v126, v146
  v_mfma_f32_32x32x16_bf16 v[188:203], v[84:87], a[224:227], v[188:203]
  ds_read_b64_tr_b16 v[116:117], v71 offset:43008
  ds_read_b64_tr_b16 v[118:119], v71 offset:43520
  buffer_load_dwordx4 a[156:159], v2, s[84:87], s34 offen offset:3072 sc1
  s_add_u32 s34, s34, 8192
  v_mfma_f32_32x32x16_bf16 v[204:219], v[88:91], a[224:227], v[204:219]
  ds_read_b64_tr_b16 v[120:121], v72 offset:43008
  ds_read_b64_tr_b16 v[122:123], v72 offset:43520
  v_add_f32 v124, v124, v148
  v_add_f32 v125, v125, v149
  v_add_f32 v126, v126, v150
  s_waitcnt lgkmcnt(8)
  v_mfma_f32_32x32x16_bf16 v[156:171], v[92:95], a[228:231], v[156:171]
  ds_read_b64_tr_b16 v[76:77], v71 offset:45056
  ds_read_b64_tr_b16 v[78:79], v71 offset:45568
  buffer_load_dwordx4 a[160:163], v2, s[84:87], s33 offen offset:0 sc1
  v_mfma_f32_32x32x16_bf16 v[172:187], v[96:99], a[228:231], v[172:187]
  ds_read_b64_tr_b16 v[80:81], v72 offset:45056
  ds_read_b64_tr_b16 v[82:83], v72 offset:45568
  v_add_f32 v124, v124, v152
  v_add_f32 v125, v125, v153
  v_add_f32 v126, v126, v154
  v_mfma_f32_32x32x16_bf16 v[188:203], v[100:103], a[228:231], v[188:203]
  ds_read_b64_tr_b16 v[84:85], v71 offset:47104
  ds_read_b64_tr_b16 v[86:87], v71 offset:47616
  buffer_load_dwordx4 a[164:167], v2, s[84:87], s34 offen offset:0 sc1
  v_mfma_f32_32x32x16_bf16 v[204:219], v[104:107], a[228:231], v[204:219]
  ds_read_b64_tr_b16 v[88:89], v72 offset:47104
  ds_read_b64_tr_b16 v[90:91], v72 offset:47616
  v_mov_b32 v128, v124
  v_mov_b32 v129, v125
  v_mov_b32 v130, v126
  s_waitcnt lgkmcnt(8)
  v_mfma_f32_32x32x16_bf16 v[156:171], v[108:111], a[232:235], v[156:171]
  ds_read_b64_tr_b16 v[92:93], v71 offset:49152
  ds_read_b64_tr_b16 v[94:95], v71 offset:49664
  buffer_load_dwordx4 a[168:171], v2, s[84:87], s33 offen offset:1024 sc1
  v_mfma_f32_32x32x16_bf16 v[172:187], v[112:115], a[232:235], v[172:187]
  ds_read_b64_tr_b16 v[96:97], v72 offset:49152
  ds_read_b64_tr_b16 v[98:99], v72 offset:49664
  v_mov_b32 v137, 0x3727c5ac
  v_permlane32_swap_b32 v124, v128
  v_permlane32_swap_b32 v125, v129
  v_mfma_f32_32x32x16_bf16 v[188:203], v[116:119], a[232:235], v[188:203]
  ds_read_b64_tr_b16 v[100:101], v71 offset:51200
  ds_read_b64_tr_b16 v[102:103], v71 offset:51712
  buffer_load_dwordx4 a[172:175], v2, s[84:87], s34 offen offset:1024 sc1
  v_mfma_f32_32x32x16_bf16 v[204:219], v[120:123], a[232:235], v[204:219]
  ds_read_b64_tr_b16 v[104:105], v72 offset:51200
  ds_read_b64_tr_b16 v[106:107], v72 offset:51712
  v_permlane32_swap_b32 v126, v130
  v_mul_f32 v132, 0x3b000000, v124
  v_fma_f32 v138, -v132, v132, v137
  ds_read_b128 v[220:223], v15 offset:0
  ds_read_b128 v[224:227], v15 offset:1024
  ds_read_b128 v[228:231], v15 offset:2048
  ds_read_b128 v[232:235], v15 offset:3072
  s_waitcnt lgkmcnt(12)
  v_mfma_f32_32x32x16_bf16 v[156:171], v[76:79], a[236:239], v[156:171]
  ds_read_b64_tr_b16 v[108:109], v71 offset:53248
  ds_read_b64_tr_b16 v[110:111], v71 offset:53760
  buffer_load_dwordx4 a[176:179], v2, s[84:87], s33 offen offset:2048 sc1
  v_mfma_f32_32x32x16_bf16 v[172:187], v[80:83], a[236:239], v[172:187]
  ds_read_b64_tr_b16 v[112:113], v72 offset:53248
  ds_read_b64_tr_b16 v[114:115], v72 offset:53760
  v_fmac_f32 v138, 0x3b000000, v125
  v_max_f32 v138, v138, v137
  v_rsq_f32_e64 v133, v138
  v_mfma_f32_32x32x16_bf16 v[188:203], v[84:87], a[236:239], v[188:203]
  ds_read_b64_tr_b16 v[116:117], v71 offset:55296
  ds_read_b64_tr_b16 v[118:119], v71 offset:55808
  buffer_load_dwordx4 a[180:183], v2, s[84:87], s34 offen offset:2048 sc1
  v_mfma_f32_32x32x16_bf16 v[204:219], v[88:91], a[236:239], v[204:219]
  ds_read_b64_tr_b16 v[120:121], v72 offset:55296
  ds_read_b64_tr_b16 v[122:123], v72 offset:55808
  v_fma_f32 v134, -v132, s50, v126
  v_fma_f32 v135, v132, s48, -v129
  v_fma_f32 v134, v134, v133, s52
  s_waitcnt lgkmcnt(12)
  v_mfma_f32_32x32x16_bf16 v[156:171], v[92:95], a[240:243], v[156:171]
  ds_read_b64_tr_b16 v[76:77], v71 offset:57344
  ds_read_b64_tr_b16 v[78:79], v71 offset:57856
  buffer_load_dwordx4 a[184:187], v2, s[84:87], s33 offen offset:3072 sc1
  s_add_u32 s33, s33, 8192
  v_mfma_f32_32x32x16_bf16 v[172:187], v[96:99], a[240:243], v[172:187]
  ds_read_b64_tr_b16 v[80:81], v72 offset:57344
  ds_read_b64_tr_b16 v[82:83], v72 offset:57856
  v_sub_f32 v135, v135, v129
  v_mul_f32 v134, 0x3b000000, v134
  v_fma_f32 v135, v135, v132, v128
  v_mfma_f32_32x32x16_bf16 v[188:203], v[100:103], a[240:243], v[188:203]
  ds_read_b64_tr_b16 v[84:85], v71 offset:59392
  ds_read_b64_tr_b16 v[86:87], v71 offset:59904
  buffer_load_dwordx4 a[188:191], v2, s[84:87], s34 offen offset:3072 sc1
  s_add_u32 s34, s34, 8192
  v_mfma_f32_32x32x16_bf16 v[204:219], v[104:107], a[240:243], v[204:219]
  ds_read_b64_tr_b16 v[88:89], v72 offset:59392
  ds_read_b64_tr_b16 v[90:91], v72 offset:59904
  v_fma_f32 v136, -v132, s49, v130
  v_add_f32 v136, v136, v136
  v_fma_f32 v135, v135, v133, v136
  s_waitcnt lgkmcnt(8)
  v_mfma_f32_32x32x16_bf16 v[156:171], v[108:111], a[244:247], v[156:171]
  ds_read_b64_tr_b16 v[92:93], v71 offset:61440
  ds_read_b64_tr_b16 v[94:95], v71 offset:61952
  buffer_load_dwordx4 a[192:195], v2, s[84:87], s33 offen offset:0 sc1
  v_mfma_f32_32x32x16_bf16 v[172:187], v[112:115], a[244:247], v[172:187]
  ds_read_b64_tr_b16 v[96:97], v72 offset:61440
  ds_read_b64_tr_b16 v[98:99], v72 offset:61952
  v_fma_f32 v135, v135, v133, s51
  v_fma_f32 v136, -v134, v134, v137
  v_fmac_f32 v136, 0x3b000000, v135
  v_mfma_f32_32x32x16_bf16 v[188:203], v[116:119], a[244:247], v[188:203]
  ds_read_b64_tr_b16 v[100:101], v71 offset:63488
  ds_read_b64_tr_b16 v[102:103], v71 offset:64000
  buffer_load_dwordx4 a[196:199], v2, s[84:87], s34 offen offset:0 sc1
  v_mfma_f32_32x32x16_bf16 v[204:219], v[120:123], a[244:247], v[204:219]
  ds_read_b64_tr_b16 v[104:105], v72 offset:63488
  ds_read_b64_tr_b16 v[106:107], v72 offset:64000
  v_max_f32 v136, v136, v137
  v_rsq_f32 v135, v136
  v_rcp_f32 v138, v133
  s_waitcnt lgkmcnt(8)
  v_mfma_f32_32x32x16_bf16 v[156:171], v[76:79], a[248:251], v[156:171]
  buffer_load_dwordx4 a[200:203], v2, s[84:87], s33 offen offset:1024 sc1
  v_mfma_f32_32x32x16_bf16 v[172:187], v[80:83], a[248:251], v[172:187]
  v_cmp_gt_u32 vcc, 32, v1
  v_mul_f32 v140, v133, v135
  v_mul_f32 v134, v134, v138
  v_rcp_f32 v139, v140
  v_cndmask_b32 v132, v134, v132, vcc
  v_cndmask_b32 v138, v4, v138, vcc
  v_mfma_f32_32x32x16_bf16 v[188:203], v[84:87], a[248:251], v[188:203]
  buffer_load_dwordx4 a[204:207], v2, s[84:87], s34 offen offset:1024 sc1
  v_mfma_f32_32x32x16_bf16 v[204:219], v[88:91], a[248:251], v[204:219]
  v_mov_b32 v150, v139
  v_cndmask_b32 v139, v4, v139, vcc
  v_sub_f32_e64 v132, 0, v132
  v_cvt_pk_bf16_f32 v152, 0, v132
  v_cvt_pk_bf16_f32 v153, 0, v138
  v_cvt_pk_bf16_f32 v154, 0, v139
  s_waitcnt lgkmcnt(0)
  v_mfma_f32_32x32x16_bf16 v[156:171], v[92:95], a[252:255], v[156:171]
  buffer_load_dwordx4 a[208:211], v2, s[84:87], s33 offen offset:2048 sc1
  v_mfma_f32_32x32x16_bf16 v[172:187], v[96:99], a[252:255], v[172:187]
  v_sub_f32 v132, v132, v152
  v_sub_f32 v138, v138, v153
  v_sub_f32 v139, v139, v154
  v_cvt_pk_bf16_f32 v144, v152, v132
  v_cvt_pk_bf16_f32 v145, v152, v153
  v_cvt_pk_bf16_f32 v146, v138, v153
  v_mfma_f32_32x32x16_bf16 v[188:203], v[100:103], a[252:255], v[188:203]
  buffer_load_dwordx4 a[212:215], v2, s[84:87], s34 offen offset:2048 sc1
  v_mfma_f32_32x32x16_bf16 v[204:219], v[104:107], a[252:255], v[204:219]
  v_cvt_pk_bf16_f32 v147, v154, v139
  v_mul_f32 v149, 0xc0135761, v140
  v_mul_f32 v140, v140, v140
  v_mul_f32 v148, 0x3d372713, v149
  v_mul_f32_e64 v148, v148, v140
  v_mfma_f32_32x32x16_bf16 v[156:171], v[220:223], v[144:147], v[156:171]
  v_mfma_f32_32x32x16_bf16 v[172:187], v[224:227], v[144:147], v[172:187]
  v_mfma_f32_32x32x16_bf16 v[188:203], v[228:231], v[144:147], v[188:203]
  v_mfma_f32_32x32x16_bf16 v[204:219], v[232:235], v[144:147], v[204:219]
  s_nop 8
  v_pk_mul_f32 v[32:33], v[156:157], v[156:157]
  v_pk_mul_f32 v[34:35], v[158:159], v[158:159]
  v_pk_mul_f32 v[36:37], v[160:161], v[160:161]
  v_pk_mul_f32 v[38:39], v[162:163], v[162:163]
  v_pk_fma_f32 v[32:33], v[32:33], v[148:149], v[148:149] op_sel:[0,0,1] op_sel_hi:[1,0,1]
  v_pk_fma_f32 v[34:35], v[34:35], v[148:149], v[148:149] op_sel:[0,0,1] op_sel_hi:[1,0,1]
  v_pk_fma_f32 v[36:37], v[36:37], v[148:149], v[148:149] op_sel:[0,0,1] op_sel_hi:[1,0,1]
  v_pk_fma_f32 v[38:39], v[38:39], v[148:149], v[148:149] op_sel:[0,0,1] op_sel_hi:[1,0,1]
  v_pk_mul_f32 v[32:33], v[32:33], v[156:157]
  v_pk_mul_f32 v[34:35], v[34:35], v[158:159]
  v_pk_mul_f32 v[36:37], v[36:37], v[160:161]
  v_pk_mul_f32 v[38:39], v[38:39], v[162:163]
  v_exp_f32 v32, v32
  v_exp_f32 v33, v33
  v_exp_f32 v34, v34
  v_exp_f32 v35, v35
  v_exp_f32 v36, v36
  v_exp_f32 v37, v37
  v_exp_f32 v38, v38
  v_exp_f32 v39, v39
  buffer_load_dwordx4 a[216:219], v2, s[84:87], s33 offen offset:3072 sc1
  s_add_u32 s33, s33, 8192
  v_pk_fma_f32 v[32:33], v[32:33], v[150:151], v[150:151] op_sel_hi:[1,0,0]
  v_pk_fma_f32 v[34:35], v[34:35], v[150:151], v[150:151] op_sel_hi:[1,0,0]
  v_pk_fma_f32 v[36:37], v[36:37], v[150:151], v[150:151] op_sel_hi:[1,0,0]
  v_pk_fma_f32 v[38:39], v[38:39], v[150:151], v[150:151] op_sel_hi:[1,0,0]
  v_rcp_f32 v32, v32
  v_rcp_f32 v33, v33
  v_rcp_f32 v34, v34
  v_rcp_f32 v35, v35
  v_rcp_f32 v36, v36
  v_rcp_f32 v37, v37
  v_rcp_f32 v38, v38
  v_rcp_f32 v39, v39
  buffer_load_dwordx4 a[220:223], v2, s[84:87], s34 offen offset:3072 sc1
  s_add_u32 s34, s34, 8192
  v_pk_mul_f32 v[32:33], v[32:33], v[156:157]
  v_pk_mul_f32 v[34:35], v[34:35], v[158:159]
  v_pk_mul_f32 v[36:37], v[36:37], v[160:161]
  v_pk_mul_f32 v[38:39], v[38:39], v[162:163]
  v_cvt_pk_bf16_f32 v76, v32, v33
  v_cvt_pk_bf16_f32 v77, v34, v35
  v_cvt_pk_bf16_f32 v78, v36, v37
  v_cvt_pk_bf16_f32 v79, v38, v39
  s_cmp_eq_u32 s96, 0
  s_cbranch_scc1 Lslow_67
  buffer_store_dwordx4 v[76:79], v14, s[84:87], s91 offen offset:0
Lse_68:
  v_pk_mul_f32 v[32:33], v[164:165], v[164:165]
  v_pk_mul_f32 v[34:35], v[166:167], v[166:167]
  v_pk_mul_f32 v[36:37], v[168:169], v[168:169]
  v_pk_mul_f32 v[38:39], v[170:171], v[170:171]
  v_pk_fma_f32 v[32:33], v[32:33], v[148:149], v[148:149] op_sel:[0,0,1] op_sel_hi:[1,0,1]
  v_pk_fma_f32 v[34:35], v[34:35], v[148:149], v[148:149] op_sel:[0,0,1] op_sel_hi:[1,0,1]
  v_pk_fma_f32 v[36:37], v[36:37], v[148:149], v[148:149] op_sel:[0,0,1] op_sel_hi:[1,0,1]
  v_pk_fma_f32 v[38:39], v[38:39], v[148:149], v[148:149] op_sel:[0,0,1] op_sel_hi:[1,0,1]
  v_pk_mul_f32 v[32:33], v[32:33], v[164:165]
  v_pk_mul_f32 v[34:35], v[34:35], v[166:167]
  v_pk_mul_f32 v[36:37], v[36:37], v[168:169]
  v_pk_mul_f32 v[38:39], v[38:39], v[170:171]
  v_exp_f32 v32, v32
  v_exp_f32 v33, v33
  v_exp_f32 v34, v34
  v_exp_f32 v35, v35
  v_exp_f32 v36, v36
  v_exp_f32 v37, v37
  v_exp_f32 v38, v38
  v_exp_f32 v39, v39
  v_pk_fma_f32 v[32:33], v[32:33], v[150:151], v[150:151] op_sel_hi:[1,0,0]
  v_pk_fma_f32 v[34:35], v[34:35], v[150:151], v[150:151] op_sel_hi:[1,0,0]
  v_pk_fma_f32 v[36:37], v[36:37], v[150:151], v[150:151] op_sel_hi:[1,0,0]
  v_pk_fma_f32 v[38:39], v[38:39], v[150:151], v[150:151] op_sel_hi:[1,0,0]
  v_rcp_f32 v32, v32
  v_rcp_f32 v33, v33
  v_rcp_f32 v34, v34
  v_rcp_f32 v35, v35
  v_rcp_f32 v36, v36
  v_rcp_f32 v37, v37
  v_rcp_f32 v38, v38
  v_rcp_f32 v39, v39
  v_pk_mul_f32 v[32:33], v[32:33], v[164:165]
  v_pk_mul_f32 v[34:35], v[34:35], v[166:167]
  v_pk_mul_f32 v[36:37], v[36:37], v[168:169]
  v_pk_mul_f32 v[38:39], v[38:39], v[170:171]
  v_cvt_pk_bf16_f32 v80, v32, v33
  v_cvt_pk_bf16_f32 v81, v34, v35
  v_cvt_pk_bf16_f32 v82, v36, v37
  v_cvt_pk_bf16_f32 v83, v38, v39
  s_cmp_eq_u32 s96, 0
  s_cbranch_scc1 Lslow_69
  buffer_store_dwordx4 v[80:83], v14, s[84:87], s91 offen offset:512
Lse_70:
  v_pk_mul_f32 v[32:33], v[172:173], v[172:173]
  v_pk_mul_f32 v[34:35], v[174:175], v[174:175]
  v_pk_mul_f32 v[36:37], v[176:177], v[176:177]
  v_pk_mul_f32 v[38:39], v[178:179], v[178:179]
  v_pk_fma_f32 v[32:33], v[32:33], v[148:149], v[148:149] op_sel:[0,0,1] op_sel_hi:[1,0,1]
  v_pk_fma_f32 v[34:35], v[34:35], v[148:149], v[148:149] op_sel:[0,0,1] op_sel_hi:[1,0,1]
  v_pk_fma_f32 v[36:37], v[36:37], v[148:149], v[148:149] op_sel:[0,0,1] op_sel_hi:[1,0,1]
  v_pk_fma_f32 v[38:39], v[38:39], v[148:149], v[148:149] op_sel:[0,0,1] op_sel_hi:[1,0,1]
  v_pk_mul_f32 v[32:33], v[32:33], v[172:173]
  v_pk_mul_f32 v[34:35], v[34:35], v[174:175]
  v_pk_mul_f32 v[36:37], v[36:37], v[176:177]
  v_pk_mul_f32 v[38:39], v[38:39], v[178:179]
  v_exp_f32 v32, v32
  v_exp_f32 v33, v33
  v_exp_f32 v34, v34
  v_exp_f32 v35, v35
  v_exp_f32 v36, v36
  v_exp_f32 v37, v37
  v_exp_f32 v38, v38
  v_exp_f32 v39, v39
  v_pk_fma_f32 v[32:33], v[32:33], v[150:151], v[150:151] op_sel_hi:[1,0,0]
  v_pk_fma_f32 v[34:35], v[34:35], v[150:151], v[150:151] op_sel_hi:[1,0,0]
  v_pk_fma_f32 v[36:37], v[36:37], v[150:151], v[150:151] op_sel_hi:[1,0,0]
  v_pk_fma_f32 v[38:39], v[38:39], v[150:151], v[150:151] op_sel_hi:[1,0,0]
  v_rcp_f32 v32, v32
  v_rcp_f32 v33, v33
  v_rcp_f32 v34, v34
  v_rcp_f32 v35, v35
  v_rcp_f32 v36, v36
  v_rcp_f32 v37, v37
  v_rcp_f32 v38, v38
  v_rcp_f32 v39, v39
  v_pk_mul_f32 v[32:33], v[32:33], v[172:173]
  v_pk_mul_f32 v[34:35], v[34:35], v[174:175]
  v_pk_mul_f32 v[36:37], v[36:37], v[176:177]
  v_pk_mul_f32 v[38:39], v[38:39], v[178:179]
  v_cvt_pk_bf16_f32 v84, v32, v33
  v_cvt_pk_bf16_f32 v85, v34, v35
  v_cvt_pk_bf16_f32 v86, v36, v37
  v_cvt_pk_bf16_f32 v87, v38, v39
  buffer_store_dwordx4 v[84:87], v14, s[84:87], s12 offen offset:2048 sc1
  v_pk_mul_f32 v[32:33], v[180:181], v[180:181]
  v_pk_mul_f32 v[34:35], v[182:183], v[182:183]
  v_pk_mul_f32 v[36:37], v[184:185], v[184:185]
  v_pk_mul_f32 v[38:39], v[186:187], v[186:187]
  v_pk_fma_f32 v[32:33], v[32:33], v[148:149], v[148:149] op_sel:[0,0,1] op_sel_hi:[1,0,1]
  v_pk_fma_f32 v[34:35], v[34:35], v[148:149], v[148:149] op_sel:[0,0,1] op_sel_hi:[1,0,1]
  v_pk_fma_f32 v[36:37], v[36:37], v[148:149], v[148:149] op_sel:[0,0,1] op_sel_hi:[1,0,1]
  v_pk_fma_f32 v[38:39], v[38:39], v[148:149], v[148:149] op_sel:[0,0,1] op_sel_hi:[1,0,1]
  v_pk_mul_f32 v[32:33], v[32:33], v[180:181]
  v_pk_mul_f32 v[34:35], v[34:35], v[182:183]
  v_pk_mul_f32 v[36:37], v[36:37], v[184:185]
  v_pk_mul_f32 v[38:39], v[38:39], v[186:187]
  v_exp_f32 v32, v32
  v_exp_f32 v33, v33
  v_exp_f32 v34, v34
  v_exp_f32 v35, v35
  v_exp_f32 v36, v36
  v_exp_f32 v37, v37
  v_exp_f32 v38, v38
  v_exp_f32 v39, v39
  v_pk_fma_f32 v[32:33], v[32:33], v[150:151], v[150:151] op_sel_hi:[1,0,0]
  v_pk_fma_f32 v[34:35], v[34:35], v[150:151], v[150:151] op_sel_hi:[1,0,0]
  v_pk_fma_f32 v[36:37], v[36:37], v[150:151], v[150:151] op_sel_hi:[1,0,0]
  v_pk_fma_f32 v[38:39], v[38:39], v[150:151], v[150:151] op_sel_hi:[1,0,0]
  v_rcp_f32 v32, v32
  v_rcp_f32 v33, v33
  v_rcp_f32 v34, v34
  v_rcp_f32 v35, v35
  v_rcp_f32 v36, v36
  v_rcp_f32 v37, v37
  v_rcp_f32 v38, v38
  v_rcp_f32 v39, v39
  v_pk_mul_f32 v[32:33], v[32:33], v[180:181]
  v_pk_mul_f32 v[34:35], v[34:35], v[182:183]
  v_pk_mul_f32 v[36:37], v[36:37], v[184:185]
  v_pk_mul_f32 v[38:39], v[38:39], v[186:187]
  v_cvt_pk_bf16_f32 v88, v32, v33
  v_cvt_pk_bf16_f32 v89, v34, v35
  v_cvt_pk_bf16_f32 v90, v36, v37
  v_cvt_pk_bf16_f32 v91, v38, v39
  buffer_store_dwordx4 v[88:91], v14, s[84:87], s12 offen offset:2560 sc1
  v_pk_mul_f32 v[32:33], v[188:189], v[188:189]
  v_pk_mul_f32 v[34:35], v[190:191], v[190:191]
  v_pk_mul_f32 v[36:37], v[192:193], v[192:193]
  v_pk_mul_f32 v[38:39], v[194:195], v[194:195]
  v_pk_fma_f32 v[32:33], v[32:33], v[148:149], v[148:149] op_sel:[0,0,1] op_sel_hi:[1,0,1]
  v_pk_fma_f32 v[34:35], v[34:35], v[148:149], v[148:149] op_sel:[0,0,1] op_sel_hi:[1,0,1]
  v_pk_fma_f32 v[36:37], v[36:37], v[148:149], v[148:149] op_sel:[0,0,1] op_sel_hi:[1,0,1]
  v_pk_fma_f32 v[38:39], v[38:39], v[148:149], v[148:149] op_sel:[0,0,1] op_sel_hi:[1,0,1]
  v_pk_mul_f32 v[32:33], v[32:33], v[188:189]
  v_pk_mul_f32 v[34:35], v[34:35], v[190:191]
  v_pk_mul_f32 v[36:37], v[36:37], v[192:193]
  v_pk_mul_f32 v[38:39], v[38:39], v[194:195]
  v_exp_f32 v32, v32
  v_exp_f32 v33, v33
  v_exp_f32 v34, v34
  v_exp_f32 v35, v35
  v_exp_f32 v36, v36
  v_exp_f32 v37, v37
  v_exp_f32 v38, v38
  v_exp_f32 v39, v39
  v_pk_fma_f32 v[32:33], v[32:33], v[150:151], v[150:151] op_sel_hi:[1,0,0]
  v_pk_fma_f32 v[34:35], v[34:35], v[150:151], v[150:151] op_sel_hi:[1,0,0]
  v_pk_fma_f32 v[36:37], v[36:37], v[150:151], v[150:151] op_sel_hi:[1,0,0]
  v_pk_fma_f32 v[38:39], v[38:39], v[150:151], v[150:151] op_sel_hi:[1,0,0]
  v_rcp_f32 v32, v32
  v_rcp_f32 v33, v33
  v_rcp_f32 v34, v34
  v_rcp_f32 v35, v35
  v_rcp_f32 v36, v36
  v_rcp_f32 v37, v37
  v_rcp_f32 v38, v38
  v_rcp_f32 v39, v39
  v_pk_mul_f32 v[32:33], v[32:33], v[188:189]
  v_pk_mul_f32 v[34:35], v[34:35], v[190:191]
  v_pk_mul_f32 v[36:37], v[36:37], v[192:193]
  v_pk_mul_f32 v[38:39], v[38:39], v[194:195]
  v_cvt_pk_bf16_f32 v92, v32, v33
  v_cvt_pk_bf16_f32 v93, v34, v35
  v_cvt_pk_bf16_f32 v94, v36, v37
  v_cvt_pk_bf16_f32 v95, v38, v39
  buffer_store_dwordx4 v[92:95], v14, s[84:87], s6 offen offset:0 sc1
  v_pk_mul_f32 v[32:33], v[196:197], v[196:197]
  v_pk_mul_f32 v[34:35], v[198:199], v[198:199]
  v_pk_mul_f32 v[36:37], v[200:201], v[200:201]
  v_pk_mul_f32 v[38:39], v[202:203], v[202:203]
  v_pk_fma_f32 v[32:33], v[32:33], v[148:149], v[148:149] op_sel:[0,0,1] op_sel_hi:[1,0,1]
  v_pk_fma_f32 v[34:35], v[34:35], v[148:149], v[148:149] op_sel:[0,0,1] op_sel_hi:[1,0,1]
  v_pk_fma_f32 v[36:37], v[36:37], v[148:149], v[148:149] op_sel:[0,0,1] op_sel_hi:[1,0,1]
  v_pk_fma_f32 v[38:39], v[38:39], v[148:149], v[148:149] op_sel:[0,0,1] op_sel_hi:[1,0,1]
  v_pk_mul_f32 v[32:33], v[32:33], v[196:197]
  v_pk_mul_f32 v[34:35], v[34:35], v[198:199]
  v_pk_mul_f32 v[36:37], v[36:37], v[200:201]
  v_pk_mul_f32 v[38:39], v[38:39], v[202:203]
  v_exp_f32 v32, v32
  v_exp_f32 v33, v33
  v_exp_f32 v34, v34
  v_exp_f32 v35, v35
  v_exp_f32 v36, v36
  v_exp_f32 v37, v37
  v_exp_f32 v38, v38
  v_exp_f32 v39, v39
  v_pk_fma_f32 v[32:33], v[32:33], v[150:151], v[150:151] op_sel_hi:[1,0,0]
  v_pk_fma_f32 v[34:35], v[34:35], v[150:151], v[150:151] op_sel_hi:[1,0,0]
  v_pk_fma_f32 v[36:37], v[36:37], v[150:151], v[150:151] op_sel_hi:[1,0,0]
  v_pk_fma_f32 v[38:39], v[38:39], v[150:151], v[150:151] op_sel_hi:[1,0,0]
  v_rcp_f32 v32, v32
  v_rcp_f32 v33, v33
  v_rcp_f32 v34, v34
  v_rcp_f32 v35, v35
  v_rcp_f32 v36, v36
  v_rcp_f32 v37, v37
  v_rcp_f32 v38, v38
  v_rcp_f32 v39, v39
  v_pk_mul_f32 v[32:33], v[32:33], v[196:197]
  v_pk_mul_f32 v[34:35], v[34:35], v[198:199]
  v_pk_mul_f32 v[36:37], v[36:37], v[200:201]
  v_pk_mul_f32 v[38:39], v[38:39], v[202:203]
  v_cvt_pk_bf16_f32 v96, v32, v33
  v_cvt_pk_bf16_f32 v97, v34, v35
  v_cvt_pk_bf16_f32 v98, v36, v37
  v_cvt_pk_bf16_f32 v99, v38, v39
  buffer_store_dwordx4 v[96:99], v14, s[84:87], s6 offen offset:512 sc1
  v_pk_mul_f32 v[32:33], v[204:205], v[204:205]
  v_pk_mul_f32 v[34:35], v[206:207], v[206:207]
  v_pk_mul_f32 v[36:37], v[208:209], v[208:209]
  v_pk_mul_f32 v[38:39], v[210:211], v[210:211]
  v_pk_fma_f32 v[32:33], v[32:33], v[148:149], v[148:149] op_sel:[0,0,1] op_sel_hi:[1,0,1]
  v_pk_fma_f32 v[34:35], v[34:35], v[148:149], v[148:149] op_sel:[0,0,1] op_sel_hi:[1,0,1]
  v_pk_fma_f32 v[36:37], v[36:37], v[148:149], v[148:149] op_sel:[0,0,1] op_sel_hi:[1,0,1]
  v_pk_fma_f32 v[38:39], v[38:39], v[148:149], v[148:149] op_sel:[0,0,1] op_sel_hi:[1,0,1]
  v_pk_mul_f32 v[32:33], v[32:33], v[204:205]
  v_pk_mul_f32 v[34:35], v[34:35], v[206:207]
  v_pk_mul_f32 v[36:37], v[36:37], v[208:209]
  v_pk_mul_f32 v[38:39], v[38:39], v[210:211]
  v_exp_f32 v32, v32
  v_exp_f32 v33, v33
  v_exp_f32 v34, v34
  v_exp_f32 v35, v35
  v_exp_f32 v36, v36
  v_exp_f32 v37, v37
  v_exp_f32 v38, v38
  v_exp_f32_e64 v39, v39
  s_waitcnt vmcnt(2)
  s_add_u32 s4, s39, 0xc000
  s_mov_b64 exec, 1
  s_cmp_eq_u32 s96, 0
  s_cbranch_scc1 Lslow_71
  buffer_store_dword v3, v4, s[84:87], s4 offen
Lse_72:
  s_mov_b64 exec, -1
  v_pk_fma_f32 v[32:33], v[32:33], v[150:151], v[150:151] op_sel_hi:[1,0,0]
  v_pk_fma_f32 v[34:35], v[34:35], v[150:151], v[150:151] op_sel_hi:[1,0,0]
  v_pk_fma_f32 v[36:37], v[36:37], v[150:151], v[150:151] op_sel_hi:[1,0,0]
  v_pk_fma_f32 v[38:39], v[38:39], v[150:151], v[150:151] op_sel_hi:[1,0,0]
  v_rcp_f32 v32, v32
  v_rcp_f32 v33, v33
  v_rcp_f32 v34, v34
  v_rcp_f32 v35, v35
  v_rcp_f32 v36, v36
  v_rcp_f32 v37, v37
  v_rcp_f32 v38, v38
  v_rcp_f32 v39, v39
  v_pk_mul_f32 v[32:33], v[32:33], v[204:205]
  v_pk_mul_f32 v[34:35], v[34:35], v[206:207]
  v_pk_mul_f32 v[36:37], v[36:37], v[208:209]
  v_pk_mul_f32 v[38:39], v[38:39], v[210:211]
  v_cvt_pk_bf16_f32 v100, v32, v33
  v_cvt_pk_bf16_f32 v101, v34, v35
  v_cvt_pk_bf16_f32 v102, v36, v37
  v_cvt_pk_bf16_f32 v103, v38, v39
  buffer_store_dwordx4 v[100:103], v14, s[84:87], s6 offen offset:2048 sc1
  v_pk_mul_f32 v[32:33], v[212:213], v[212:213]
  v_pk_mul_f32 v[34:35], v[214:215], v[214:215]
  v_pk_mul_f32 v[36:37], v[216:217], v[216:217]
  v_pk_mul_f32 v[38:39], v[218:219], v[218:219]
  v_pk_fma_f32 v[32:33], v[32:33], v[148:149], v[148:149] op_sel:[0,0,1] op_sel_hi:[1,0,1]
  v_pk_fma_f32 v[34:35], v[34:35], v[148:149], v[148:149] op_sel:[0,0,1] op_sel_hi:[1,0,1]
  v_pk_fma_f32 v[36:37], v[36:37], v[148:149], v[148:149] op_sel:[0,0,1] op_sel_hi:[1,0,1]
  v_pk_fma_f32 v[38:39], v[38:39], v[148:149], v[148:149] op_sel:[0,0,1] op_sel_hi:[1,0,1]
  v_pk_mul_f32 v[32:33], v[32:33], v[212:213]
  v_pk_mul_f32 v[34:35], v[34:35], v[214:215]
  v_pk_mul_f32 v[36:37], v[36:37], v[216:217]
  v_pk_mul_f32 v[38:39], v[38:39], v[218:219]
  v_exp_f32 v32, v32
  v_exp_f32 v33, v33
  v_exp_f32 v34, v34
  v_exp_f32 v35, v35
  v_exp_f32 v36, v36
  v_exp_f32 v37, v37
  v_exp_f32 v38, v38
  v_exp_f32 v39, v39
  v_pk_fma_f32 v[32:33], v[32:33], v[150:151], v[150:151] op_sel_hi:[1,0,0]
  v_pk_fma_f32 v[34:35], v[34:35], v[150:151], v[150:151] op_sel_hi:[1,0,0]
  v_pk_fma_f32 v[36:37], v[36:37], v[150:151], v[150:151] op_sel_hi:[1,0,0]
  v_pk_fma_f32 v[38:39], v[38:39], v[150:151], v[150:151] op_sel_hi:[1,0,0]
  v_rcp_f32 v32, v32
  v_rcp_f32 v33, v33
  v_rcp_f32 v34, v34
  v_rcp_f32 v35, v35
  v_rcp_f32 v36, v36
  v_rcp_f32 v37, v37
  v_rcp_f32 v38, v38
  v_rcp_f32 v39, v39
  v_pk_mul_f32 v[32:33], v[32:33], v[212:213]
  v_pk_mul_f32 v[34:35], v[34:35], v[214:215]
  v_pk_mul_f32 v[36:37], v[36:37], v[216:217]
  v_pk_mul_f32 v[38:39], v[38:39], v[218:219]
  v_cvt_pk_bf16_f32 v104, v32, v33
  v_cvt_pk_bf16_f32 v105, v34, v35
  v_cvt_pk_bf16_f32 v106, v36, v37
  v_cvt_pk_bf16_f32 v107, v38, v39
  buffer_load_dword v54, v50, s[84:87], s26 offen sc1
  buffer_store_dwordx4 v[104:107], v14, s[84:87], s6 offen offset:2560 sc1
Lback_60:
  s_waitcnt vmcnt(1)
  v_cmp_ne_u32 vcc, s95, v54
  s_nop 0
  s_cmp_lg_u64 vcc, 0
  s_cbranch_scc1 Lre_76
Lok_77:
  buffer_load_dwordx4 v[32:35], v2, s[84:87], s30 offen offset:0 sc1
  buffer_load_dwordx4 v[36:39], v2, s[84:87], s29 offen offset:0 sc1
  buffer_load_dwordx4 v[56:59], v2, s[84:87], s30 offen offset:1024 sc1
  buffer_load_dwordx4 v[60:63], v2, s[84:87], s29 offen offset:1024 sc1
  buffer_load_dwordx4 v[64:67], v2, s[84:87], s28 offen offset:2048 sc1
  buffer_load_dwordx4 v[68:71], v2, s[84:87], s7 offen offset:2048 sc1
  buffer_load_dwordx4 v[108:111], v2, s[84:87], s28 offen offset:3072 sc1
  s_add_u32 s28, s28, 8192
  s_add_u32 s30, s30, 2048
  buffer_load_dwordx4 v[112:115], v2, s[84:87], s7 offen offset:3072 sc1
  s_add_u32 s7, s7, 8192
  s_add_u32 s29, s29, 2048
  s_waitcnt vmcnt(8)
  s_add_u32 s4, s39, 0xc100
  s_mov_b64 exec, 1
  s_cmp_eq_u32 s96, 0
  s_cbranch_scc1 Lslow_79
  buffer_store_dword v3, v4, s[84:87], s4 offen
Lse_80:
  s_mov_b64 exec, -1
  s_waitcnt vmcnt(8)
  v_mfma_f32_32x32x16_bf16 v[148:163], a[4:7], v[32:35], 0
  buffer_load_dwordx4 v[116:119], v2, s[84:87], s30 offen offset:0 sc1
  v_mfma_f32_32x32x16_bf16 v[132:147], a[0:3], v[32:35], 0
  ds_read_b128 v[164:167], v75 offset:768
  ds_read_b128 v[168:171], v75 offset:784
  s_waitcnt vmcnt(8)
  v_mfma_f32_32x32x16_bf16 v[92:107], a[4:7], v[36:39], 0
  buffer_load_dwordx4 v[120:123], v2, s[84:87], s29 offen offset:0 sc1
  v_mfma_f32_32x32x16_bf16 v[76:91], a[0:3], v[36:39], 0
  ds_read_b128 v[172:175], v75 offset:800
  ds_read_b128 v[176:179], v75 offset:816
  s_waitcnt vmcnt(8)
  v_mfma_f32_32x32x16_bf16 v[148:163], a[12:15], v[56:59], v[148:163]
  buffer_load_dwordx4 v[124:127], v2, s[84:87], s30 offen offset:1024 sc1
  v_mfma_f32_32x32x16_bf16 v[132:147], a[8:11], v[56:59], v[132:147]
  v_lshlrev_b32 v180, 16, v42
  v_and_b32 v181, 0xffff0000, v42
  s_waitcnt vmcnt(8)
  v_mfma_f32_32x32x16_bf16 v[92:107], a[12:15], v[60:63], v[92:107]
  buffer_load_dwordx4 v[128:131], v2, s[84:87], s29 offen offset:1024 sc1
  v_mfma_f32_32x32x16_bf16 v[76:91], a[8:11], v[60:63], v[76:91]
  v_lshlrev_b32 v182, 16, v43
  v_and_b32 v183, 0xffff0000, v43
  s_waitcnt vmcnt(8)
  v_mfma_f32_32x32x16_bf16 v[148:163], a[20:23], v[64:67], v[148:163]
  buffer_load_dwordx4 v[32:35], v2, s[84:87], s28 offen offset:2048 sc1
  v_mfma_f32_32x32x16_bf16 v[132:147], a[16:19], v[64:67], v[132:147]
  v_lshlrev_b32 v184, 16, v44
  v_and_b32 v185, 0xffff0000, v44
  s_waitcnt vmcnt(8)
  v_mfma_f32_32x32x16_bf16 v[92:107], a[20:23], v[68:71], v[92:107]
  buffer_load_dwordx4 v[36:39], v2, s[84:87], s7 offen offset:2048 sc1
  v_mfma_f32_32x32x16_bf16 v[76:91], a[16:19], v[68:71], v[76:91]
  v_lshlrev_b32 v186, 16, v45
  v_and_b32 v187, 0xffff0000, v45
  s_waitcnt vmcnt(8)
  v_mfma_f32_32x32x16_bf16 v[148:163], a[28:31], v[108:111], v[148:163]
  buffer_load_dwordx4 v[56:59], v2, s[84:87], s28 offen offset:3072 sc1
  s_add_u32 s28, s28, 8192
  s_add_u32 s30, s30, 2048
  v_mfma_f32_32x32x16_bf16 v[132:147], a[24:27], v[108:111], v[132:147]
  v_lshlrev_b32 v188, 16, v46
  v_and_b32 v189, 0xffff0000, v46
  s_waitcnt vmcnt(8)
  v_mfma_f32_32x32x16_bf16 v[92:107], a[28:31], v[112:115], v[92:107]
  buffer_load_dwordx4 v[60:63], v2, s[84:87], s7 offen offset:3072 sc1
  s_add_u32 s7, s7, 8192
  s_add_u32 s29, s29, 2048
  v_mfma_f32_32x32x16_bf16 v[76:91], a[24:27], v[112:115], v[76:91]
  v_lshlrev_b32 v190, 16, v47
  v_and_b32 v191, 0xffff0000, v47
  s_waitcnt vmcnt(7)
  v_mfma_f32_32x32x16_bf16 v[148:163], a[36:39], v[116:119], v[148:163]
  buffer_load_dwordx4 v[64:67], v2, s[84:87], s30 offen offset:0 sc1
  v_mfma_f32_32x32x16_bf16 v[132:147], a[32:35], v[116:119], v[132:147]
  v_lshlrev_b32 v192, 16, v48
  v_and_b32 v193, 0xffff0000, v48
  s_waitcnt vmcnt(7)
  v_mfma_f32_32x32x16_bf16 v[92:107], a[36:39], v[120:123], v[92:107]
  buffer_load_dwordx4 v[68:71], v2, s[84:87], s29 offen offset:0 sc1
  v_mfma_f32_32x32x16_bf16 v[76:91], a[32:35], v[120:123], v[76:91]
  v_lshlrev_b32 v194, 16, v49
  v_and_b32 v195, 0xffff0000, v49
  s_waitcnt vmcnt(7)
  v_mfma_f32_32x32x16_bf16 v[148:163], a[44:47], v[124:127], v[148:163]
  buffer_load_dwordx4 v[108:111], v2, s[84:87], s30 offen offset:1024 sc1
  v_mfma_f32_32x32x16_bf16 v[132:147], a[40:43], v[124:127], v[132:147]
  s_waitcnt lgkmcnt(3)
  v_pk_fma_f32 v[16:17], v[180:181], v[164:165], v[16:17]
  v_pk_fma_f32 v[18:19], v[182:183], v[166:167], v[18:19]
  s_waitcnt vmcnt(7)
  v_mfma_f32_32x32x16_bf16 v[92:107], a[44:47], v[128:131], v[92:107]
  buffer_load_dwordx4 v[112:115], v2, s[84:87], s29 offen offset:1024 sc1
  v_mfma_f32_32x32x16_bf16 v[76:91], a[40:43], v[128:131], v[76:91]
  s_waitcnt lgkmcnt(2)
  v_pk_fma_f32 v[20:21], v[184:185], v[168:169], v[20:21]
  v_pk_fma_f32 v[22:23], v[186:187], v[170:171], v[22:23]
  s_waitcnt vmcnt(7)
  v_mfma_f32_32x32x16_bf16 v[148:163], a[52:55], v[32:35], v[148:163]
  buffer_load_dwordx4 v[116:119], v2, s[84:87], s28 offen offset:2048 sc1
  v_mfma_f32_32x32x16_bf16 v[132:147], a[48:51], v[32:35], v[132:147]
  s_waitcnt lgkmcnt(1)
  v_pk_fma_f32 v[24:25], v[188:189], v[172:173], v[24:25]
  v_pk_fma_f32 v[26:27], v[190:191], v[174:175], v[26:27]
  buffer_load_dword v54, v50, s[84:87], s26 offen offset:256 sc1
  s_waitcnt vmcnt(8)
  v_mfma_f32_32x32x16_bf16 v[92:107], a[52:55], v[36:39], v[92:107]
  buffer_load_dwordx4 v[120:123], v2, s[84:87], s7 offen offset:2048 sc1
  v_mfma_f32_32x32x16_bf16 v[76:91], a[48:51], v[36:39], v[76:91]
  s_waitcnt lgkmcnt(0)
  v_pk_fma_f32 v[28:29], v[192:193], v[176:177], v[28:29]
  v_pk_fma_f32 v[30:31], v[194:195], v[178:179], v[30:31]
  s_waitcnt vmcnt(8)
  v_mfma_f32_32x32x16_bf16 v[148:163], a[60:63], v[56:59], v[148:163]
  buffer_load_dwordx4 v[124:127], v2, s[84:87], s28 offen offset:3072 sc1
  s_add_u32 s28, s28, s35
  s_add_u32 s30, s30, 2048
  v_mfma_f32_32x32x16_bf16 v[132:147], a[56:59], v[56:59], v[132:147]
  s_xor_b32 s98, s92, 2
  s_mul_i32 s98, s98, 12288
  s_waitcnt vmcnt(8)
  v_mfma_f32_32x32x16_bf16 v[92:107], a[60:63], v[60:63], v[92:107]
  buffer_load_dwordx4 v[128:131], v2, s[84:87], s7 offen offset:3072 sc1
  s_add_u32 s7, s7, s35
  s_add_u32 s29, s29, 2048
  v_mfma_f32_32x32x16_bf16 v[76:91], a[56:59], v[60:63], v[76:91]
  v_add_u32 v196, s98, v2
  s_xor_b32 s98, s92, 1
  s_waitcnt vmcnt(8)
  v_mfma_f32_32x32x16_bf16 v[148:163], a[68:71], v[64:67], v[148:163]
  s_waitcnt vmcnt(3)
  v_cmp_ne_u32 vcc, s95, v54
  s_nop 0
  s_cmp_lg_u64 vcc, 0
  s_cbranch_scc1 Lre_81
Lok_82:
  s_bitcmp0_b32 s92, 0
  s_cselect_b32 s30, s30, s28
  buffer_load_dwordx4 v[32:35], v2, s[84:87], s30 offen offset:0 sc1
  v_mfma_f32_32x32x16_bf16 v[132:147], a[64:67], v[64:67], v[132:147]
  s_mul_i32 s98, s98, 12288
  v_add_u32 v197, s98, v2
  v_mfma_f32_32x32x16_bf16 v[92:107], a[68:71], v[68:71], v[92:107]
  s_bitcmp0_b32 s92, 0
  s_cselect_b32 s29, s29, s7
  buffer_load_dwordx4 v[36:39], v2, s[84:87], s29 offen offset:0 sc1
  v_mfma_f32_32x32x16_bf16 v[76:91], a[64:67], v[68:71], v[76:91]
  v_add_u32 v197, 4096, v197
  s_xor_b32 s98, s92, 3
  v_mfma_f32_32x32x16_bf16 v[148:163], a[76:79], v[108:111], v[148:163]
  buffer_load_dwordx4 v[56:59], v2, s[84:87], s30 offen offset:1024 sc1
  v_mfma_f32_32x32x16_bf16 v[132:147], a[72:75], v[108:111], v[132:147]
  s_mul_i32 s98, s98, 12288
  v_add_u32 v198, s98, v2
  v_mfma_f32_32x32x16_bf16 v[92:107], a[76:79], v[112:115], v[92:107]
  buffer_load_dwordx4 v[60:63], v2, s[84:87], s29 offen offset:1024 sc1
  v_mfma_f32_32x32x16_bf16 v[76:91], a[72:75], v[112:115], v[76:91]
  v_add_u32 v198, 8192, v198
  s_xor_b32 s98, s92, 0
  v_mfma_f32_32x32x16_bf16 v[148:163], a[84:87], v[116:119], v[148:163]
  buffer_load_dwordx4 v[64:67], v2, s[84:87], s28 offen offset:2048 sc1
  v_mfma_f32_32x32x16_bf16 v[132:147], a[80:83], v[116:119], v[132:147]
  s_mul_i32 s98, s98, 12288
  v_add_u32 v199, s98, v2
  s_waitcnt vmcnt(7)
  v_mfma_f32_32x32x16_bf16 v[92:107], a[84:87], v[120:123], v[92:107]
  buffer_load_dwordx4 v[68:71], v2, s[84:87], s7 offen offset:2048 sc1
  v_mfma_f32_32x32x16_bf16 v[76:91], a[80:83], v[120:123], v[76:91]
  s_waitcnt vmcnt(7)
  v_mfma_f32_32x32x16_bf16 v[148:163], a[92:95], v[124:127], v[148:163]
  buffer_load_dwordx4 v[108:111], v2, s[84:87], s28 offen offset:3072 sc1
  s_add_u32 s28, s28, s36
  v_mfma_f32_32x32x16_bf16 v[132:147], a[88:91], v[124:127], v[132:147]
  s_waitcnt vmcnt(7)
  v_mfma_f32_32x32x16_bf16 v[92:107], a[92:95], v[128:131], v[92:107]
  buffer_load_dwordx4 v[112:115], v2, s[84:87], s7 offen offset:3072 sc1
  s_add_u32 s7, s7, s36
  v_mfma_f32_32x32x16_bf16 v[76:91], a[88:91], v[128:131], v[76:91]
  s_waitcnt vmcnt(7)
  v_mfma_f32_32x32x16_bf16 v[148:163], a[100:103], v[32:35], v[148:163]
  buffer_load_dwordx4 v[116:119], v2, s[84:87], s28 offen offset:0 sc1
  v_mfma_f32_32x32x16_bf16 v[132:147], a[96:99], v[32:35], v[132:147]
  s_waitcnt vmcnt(7)
  v_mfma_f32_32x32x16_bf16 v[92:107], a[100:103], v[36:39], v[92:107]
  buffer_load_dwordx4 v[120:123], v2, s[84:87], s7 offen offset:0 sc1
  v_mfma_f32_32x32x16_bf16 v[76:91], a[96:99], v[36:39], v[76:91]
  s_waitcnt vmcnt(7)
  v_mfma_f32_32x32x16_bf16 v[148:163], a[108:111], v[56:59], v[148:163]
  buffer_load_dwordx4 v[124:127], v2, s[84:87], s28 offen offset:1024 sc1
  v_mfma_f32_32x32x16_bf16 v[132:147], a[104:107], v[56:59], v[132:147]
  s_waitcnt vmcnt(7)
  v_mfma_f32_32x32x16_bf16 v[92:107], a[108:111], v[60:63], v[92:107]
  buffer_load_dwordx4 v[128:131], v2, s[84:87], s7 offen offset:1024 sc1
  v_mfma_f32_32x32x16_bf16 v[76:91], a[104:107], v[60:63], v[76:91]
  s_waitcnt vmcnt(7)
  v_mfma_f32_32x32x16_bf16 v[148:163], a[116:119], v[64:67], v[148:163]
  buffer_load_dwordx4 v[32:35], v2, s[84:87], s28 offen offset:2048 sc1
  v_mfma_f32_32x32x16_bf16 v[132:147], a[112:115], v[64:67], v[132:147]
  s_waitcnt vmcnt(7)
  v_mfma_f32_32x32x16_bf16 v[92:107], a[116:119], v[68:71], v[92:107]
  buffer_load_dwordx4 v[36:39], v2, s[84:87], s7 offen offset:2048 sc1
  v_mfma_f32_32x32x16_bf16 v[76:91], a[112:115], v[68:71], v[76:91]
  s_waitcnt vmcnt(7)
  v_mfma_f32_32x32x16_bf16 v[148:163], a[124:127], v[108:111], v[148:163]
  buffer_load_dwordx4 v[56:59], v2, s[84:87], s28 offen offset:3072 sc1
  s_add_u32 s28, s28, 8192
  v_mfma_f32_32x32x16_bf16 v[132:147], a[120:123], v[108:111], v[132:147]
  s_barrier
  s_waitcnt vmcnt(7)
  v_mfma_f32_32x32x16_bf16 v[92:107], a[124:127], v[112:115], v[92:107]
  buffer_load_dwordx4 v[60:63], v2, s[84:87], s7 offen offset:3072 sc1
  s_add_u32 s7, s7, 8192
  v_mfma_f32_32x32x16_bf16 v[76:91], a[120:123], v[112:115], v[76:91]
  s_waitcnt vmcnt(7)
  v_mfma_f32_32x32x16_bf16 v[148:163], a[132:135], v[116:119], v[148:163]
  buffer_load_dwordx4 v[64:67], v2, s[84:87], s28 offen offset:0 sc1
  v_mfma_f32_32x32x16_bf16 v[132:147], a[128:131], v[116:119], v[132:147]
  s_waitcnt vmcnt(7)
  v_mfma_f32_32x32x16_bf16 v[92:107], a[132:135], v[120:123], v[92:107]
  buffer_load_dwordx4 v[68:71], v2, s[84:87], s7 offen offset:0 sc1
  v_mfma_f32_32x32x16_bf16 v[76:91], a[128:131], v[120:123], v[76:91]
  s_waitcnt vmcnt(7)
  v_mfma_f32_32x32x16_bf16 v[148:163], a[140:143], v[124:127], v[148:163]
  buffer_load_dwordx4 v[108:111], v2, s[84:87], s28 offen offset:1024 sc1
  v_mfma_f32_32x32x16_bf16 v[132:147], a[136:139], v[124:127], v[132:147]
  s_waitcnt vmcnt(7)
  v_mfma_f32_32x32x16_bf16 v[92:107], a[140:143], v[128:131], v[92:107]
  buffer_load_dwordx4 v[112:115], v2, s[84:87], s7 offen offset:1024 sc1
  v_mfma_f32_32x32x16_bf16 v[76:91], a[136:139], v[128:131], v[76:91]
  s_waitcnt vmcnt(7)
  v_mfma_f32_32x32x16_bf16 v[148:163], a[148:151], v[32:35], v[148:163]
  buffer_load_dwordx4 v[116:119], v2, s[84:87], s28 offen offset:2048 sc1
  v_mfma_f32_32x32x16_bf16 v[132:147], a[144:147], v[32:35], v[132:147]
  s_waitcnt vmcnt(7)
  v_mfma_f32_32x32x16_bf16 v[92:107], a[148:151], v[36:39], v[92:107]
  buffer_load_dwordx4 v[120:123], v2, s[84:87], s7 offen offset:2048 sc1
  v_mfma_f32_32x32x16_bf16 v[76:91], a[144:147], v[36:39], v[76:91]
  s_waitcnt vmcnt(7)
  v_mfma_f32_32x32x16_bf16 v[148:163], a[156:159], v[56:59], v[148:163]
  buffer_load_dwordx4 v[124:127], v2, s[84:87], s28 offen offset:3072 sc1
  s_add_u32 s28, s28, 8192
  v_mfma_f32_32x32x16_bf16 v[132:147], a[152:155], v[56:59], v[132:147]
  s_waitcnt vmcnt(7)
  v_mfma_f32_32x32x16_bf16 v[92:107], a[156:159], v[60:63], v[92:107]
  buffer_load_dwordx4 v[128:131], v2, s[84:87], s28 offen offset:0 sc1
  v_mfma_f32_32x32x16_bf16 v[76:91], a[152:155], v[60:63], v[76:91]
  s_waitcnt vmcnt(7)
  v_mfma_f32_32x32x16_bf16 v[148:163], a[164:167], v[64:67], v[148:163]
  buffer_load_dwordx4 v[32:35], v2, s[84:87], s28 offen offset:1024 sc1
  v_mfma_f32_32x32x16_bf16 v[132:147], a[160:163], v[64:67], v[132:147]
  s_waitcnt vmcnt(7)
  v_mfma_f32_32x32x16_bf16 v[92:107], a[164:167], v[68:71], v[92:107]
  buffer_load_dwordx4 v[36:39], v2, s[84:87], s28 offen offset:2048 sc1
  v_mfma_f32_32x32x16_bf16 v[76:91], a[160:163], v[68:71], v[76:91]
  s_waitcnt vmcnt(7)
  v_mfma_f32_32x32x16_bf16 v[148:163], a[172:175], v[108:111], v[148:163]
  buffer_load_dwordx4 v[56:59], v2, s[84:87], s28 offen offset:3072 sc1
  s_add_u32 s28, s28, 8192
  v_mfma_f32_32x32x16_bf16 v[132:147], a[168:171], v[108:111], v[132:147]
  s_waitcnt vmcnt(7)
  v_mfma_f32_32x32x16_bf16 v[92:107], a[172:175], v[112:115], v[92:107]
  buffer_load_dwordx4 v[60:63], v2, s[84:87], s7 offen offset:3072 sc1
  s_add_u32 s7, s7, 8192
  v_mfma_f32_32x32x16_bf16 v[76:91], a[168:171], v[112:115], v[76:91]
  s_waitcnt vmcnt(7)
  v_mfma_f32_32x32x16_bf16 v[148:163], a[180:183], v[116:119], v[148:163]
  buffer_load_dwordx4 v[64:67], v2, s[84:87], s7 offen offset:0 sc1
  v_mfma_f32_32x32x16_bf16 v[132:147], a[176:179], v[116:119], v[132:147]
  s_waitcnt vmcnt(7)
  v_mfma_f32_32x32x16_bf16 v[92:107], a[180:183], v[120:123], v[92:107]
  buffer_load_dwordx4 v[68:71], v2, s[84:87], s7 offen offset:1024 sc1
  v_mfma_f32_32x32x16_bf16 v[76:91], a[176:179], v[120:123], v[76:91]
  s_waitcnt vmcnt(7)
  v_mfma_f32_32x32x16_bf16 v[148:163], a[188:191], v[124:127], v[148:163]
  buffer_load_dwordx4 v[108:111], v2, s[84:87], s7 offen offset:2048 sc1
  v_mfma_f32_32x32x16_bf16 v[132:147], a[184:187], v[124:127], v[132:147]
  s_waitcnt vmcnt(7)
  v_mfma_f32_32x32x16_bf16 v[148:163], a[196:199], v[128:131], v[148:163]
  buffer_load_dwordx4 v[112:115], v2, s[84:87], s7 offen offset:3072 sc1
  s_add_u32 s7, s7, 8192
  v_mfma_f32_32x32x16_bf16 v[132:147], a[192:195], v[128:131], v[132:147]
  s_or_b32 s98, s2, s92
  s_cmp_eq_u32 s98, 0
  s_cselect_b64 exec, 1, 0
  buffer_store_dword v3, v4, s[84:87], 0 offen sc1
  s_mov_b64 exec, -1
  s_waitcnt vmcnt(8)
  v_mfma_f32_32x32x16_bf16 v[148:163], a[204:207], v[32:35], v[148:163]
  v_mfma_f32_32x32x16_bf16 v[132:147], a[200:203], v[32:35], v[132:147]
  s_waitcnt vmcnt(7)
  v_mfma_f32_32x32x16_bf16 v[148:163], a[212:215], v[36:39], v[148:163]
  v_mfma_f32_32x32x16_bf16 v[132:147], a[208:211], v[36:39], v[132:147]
  s_waitcnt vmcnt(6)
  v_mfma_f32_32x32x16_bf16 v[148:163], a[220:223], v[56:59], v[148:163]
  v_mfma_f32_32x32x16_bf16 v[132:147], a[216:219], v[56:59], v[132:147]
  s_waitcnt vmcnt(5)
  v_mfma_f32_32x32x16_bf16 v[92:107], a[188:191], v[60:63], v[92:107]
  v_mfma_f32_32x32x16_bf16 v[76:91], a[184:187], v[60:63], v[76:91]
  s_waitcnt vmcnt(4)
  v_mfma_f32_32x32x16_bf16 v[92:107], a[196:199], v[64:67], v[92:107]
  s_nop 5
  ds_write_b128 v198, v[148:151] offset:0
  v_mfma_f32_32x32x16_bf16 v[76:91], a[192:195], v[64:67], v[76:91]
  ds_write_b128 v198, v[152:155] offset:1024
  s_waitcnt vmcnt(3)
  v_mfma_f32_32x32x16_bf16 v[92:107], a[204:207], v[68:71], v[92:107]
  ds_write_b128 v198, v[156:159] offset:2048
  v_mfma_f32_32x32x16_bf16 v[76:91], a[200:203], v[68:71], v[76:91]
  ds_write_b128 v198, v[160:163] offset:3072
  s_waitcnt vmcnt(2)
  v_mfma_f32_32x32x16_bf16 v[92:107], a[212:215], v[108:111], v[92:107]
  ds_write_b128 v196, v[132:135] offset:0
  v_mfma_f32_32x32x16_bf16 v[76:91], a[208:211], v[108:111], v[76:91]
  ds_write_b128 v196, v[136:139] offset:1024
  s_waitcnt vmcnt(1)
  v_mfma_f32_32x32x16_bf16 v[92:107], a[220:223], v[112:115], v[92:107]
  ds_write_b128 v196, v[140:143] offset:2048
  v_mfma_f32_32x32x16_bf16 v[76:91], a[216:219], v[112:115], v[76:91]
  ds_write_b128 v196, v[144:147] offset:3072
  s_nop 8
  ds_write_b128 v197, v[92:95] offset:0
  ds_write_b128 v197, v[96:99] offset:1024
  ds_write_b128 v197, v[100:103] offset:2048
  ds_write_b128 v197, v[104:107] offset:3072
  s_waitcnt lgkmcnt(0)
  s_barrier
  ds_read_b128 v[132:135], v199 offset:0
  ds_read_b128 v[92:95], v199 offset:4096
  ds_read_b128 v[148:151], v199 offset:8192
  ds_read_b128 v[136:139], v199 offset:1024
  ds_read_b128 v[96:99], v199 offset:5120
  ds_read_b128 v[152:155], v199 offset:9216
  ds_read_b128 v[140:143], v199 offset:2048
  ds_read_b128 v[100:103], v199 offset:6144
  ds_read_b128 v[156:159], v199 offset:10240
  ds_read_b128 v[144:147], v199 offset:3072
  ds_read_b128 v[104:107], v199 offset:7168
  ds_read_b128 v[160:163], v199 offset:11264
  s_waitcnt lgkmcnt(11)
  v_pk_add_f32 v[76:77], v[76:77], v[132:133]
  v_pk_add_f32 v[78:79], v[78:79], v[134:135]
  s_waitcnt lgkmcnt(8)
  v_pk_add_f32 v[80:81], v[80:81], v[136:137]
  v_pk_add_f32 v[82:83], v[82:83], v[138:139]
  v_pk_add_f32 v[76:77], v[76:77], v[92:93]
  v_pk_add_f32 v[78:79], v[78:79], v[94:95]
  s_waitcnt lgkmcnt(7)
  v_pk_add_f32 v[80:81], v[80:81], v[96:97]
  v_pk_add_f32 v[82:83], v[82:83], v[98:99]
  v_pk_add_f32 v[76:77], v[76:77], v[148:149]
  v_pk_add_f32 v[78:79], v[78:79], v[150:151]
  s_waitcnt lgkmcnt(6)
  v_pk_add_f32 v[80:81], v[80:81], v[152:153]
  v_pk_add_f32 v[82:83], v[82:83], v[154:155]
  v_pk_fma_f32 v[16:17], v[76:77], v[164:165], v[16:17]
  v_pk_fma_f32 v[18:19], v[78:79], v[166:167], v[18:19]
  v_pk_fma_f32 v[20:21], v[80:81], v[168:169], v[20:21]
  v_pk_fma_f32 v[22:23], v[82:83], v[170:171], v[22:23]
  v_cvt_pk_bf16_f32 v42, v16, v17
  v_cvt_pk_bf16_f32 v43, v18, v19
  v_cvt_pk_bf16_f32 v44, v20, v21
  v_cvt_pk_bf16_f32 v45, v22, v23
  buffer_store_dwordx4 v[42:45], v53, s[80:83], s22 offen offset:0
  s_waitcnt lgkmcnt(5)
  v_pk_add_f32 v[84:85], v[84:85], v[140:141]
  v_pk_add_f32 v[86:87], v[86:87], v[142:143]
  s_waitcnt lgkmcnt(2)
  v_pk_add_f32 v[88:89], v[88:89], v[144:145]
  v_pk_add_f32 v[90:91], v[90:91], v[146:147]
  v_pk_add_f32 v[84:85], v[84:85], v[100:101]
  v_pk_add_f32 v[86:87], v[86:87], v[102:103]
  s_waitcnt lgkmcnt(1)
  v_pk_add_f32 v[88:89], v[88:89], v[104:105]
  v_pk_add_f32 v[90:91], v[90:91], v[106:107]
  v_pk_add_f32 v[84:85], v[84:85], v[156:157]
  v_pk_add_f32 v[86:87], v[86:87], v[158:159]
  s_waitcnt lgkmcnt(0)
  v_pk_add_f32 v[88:89], v[88:89], v[160:161]
  v_pk_add_f32 v[90:91], v[90:91], v[162:163]
  v_pk_fma_f32 v[24:25], v[84:85], v[172:173], v[24:25]
  v_pk_fma_f32 v[26:27], v[86:87], v[174:175], v[26:27]
  v_pk_fma_f32 v[28:29], v[88:89], v[176:177], v[28:29]
  v_pk_fma_f32 v[30:31], v[90:91], v[178:179], v[30:31]
  v_cvt_pk_bf16_f32 v46, v24, v25
  v_cvt_pk_bf16_f32 v47, v26, v27
  v_cvt_pk_bf16_f32 v48, v28, v29
  v_cvt_pk_bf16_f32 v49, v30, v31
  buffer_store_dwordx4 v[46:49], v53, s[80:83], s22 offen offset:16
Lexit:
  s_endpgm
L_1:
  ds_read_b32 v40, v77 offset:0
  ds_read_b32 v41, v77 offset:256
  ds_read_b32 v42, v77 offset:512
  ds_read_b32 v43, v77 offset:768
  s_cmp_lt_u32 s2, 64
  s_waitcnt lgkmcnt(0)
  v_add_f32 v40, v40, v41
  v_add_f32 v42, v42, v43
  v_add_f32 v40, v40, v42
  v_mov_b32 v41, v3
  s_cselect_b64 exec, -1, 0
  buffer_store_dwordx2 v[40:41], v78, s[84:87], s10 offen sc1
  s_sub_u32 s4, s2, 64
  s_cmp_lt_u32 s4, 128
  s_cselect_b64 exec, -1, 0
  buffer_store_dword v40, v2, s[84:87], s11 offen sc1
  s_mov_b64 exec, -1
  s_nop 0
  s_branch L_4
L_2:
  s_mov_b64 exec, 0xff
  ds_read_b64 v[40:41], v79
  v_mov_b32 v11, 0x3727c5ac
  v_mov_b32 v38, s5
  v_mov_b32 v39, v3
  s_waitcnt lgkmcnt(0)
  v_mul_f32 v36, 0x3b000000, v40
  v_fma_f32 v40, -v36, v36, v11
  v_fmac_f32 v40, 0x3b000000, v41
  v_max_f32 v40, v40, v11
  v_rsq_f32 v37, v40
  s_nop 0
  buffer_store_dwordx4 v[36:39], v2, s[84:87], s79 offen sc1
  s_mov_b64 exec, -1
  s_nop 1
  s_branch L_4
Lslow_6:
  buffer_store_dwordx4 v[30:33], v2, s[84:87], s91 offen sc1
  buffer_store_dwordx4 v[34:37], v2, s[84:87], s91 offen offset:1024 sc1
  s_nop 1
  s_branch Lse_7
Lslow_8:
  buffer_store_dword v3, v4, s[84:87], s4 offen sc1
  s_nop 1
  s_branch Lse_9
Lre_13:
  s_mov_b32 s97, 20000
Lrp_15:
  buffer_load_dwordx4 v[126:129], v2, s[84:87], s77 offen sc1
  s_waitcnt vmcnt(0)
  v_xor_b32 v126, v3, v126
  v_bitop3_b32 v126, v126, v127, v3 bitop3:0xf6
  v_bitop3_b32 v126, v126, v128, v3 bitop3:0xf6
  v_bitop3_b32 v126, v126, v129, v3 bitop3:0xf6
  v_cmp_ne_u32 vcc, 0, v126
  s_sub_u32 s97, s97, 1
  s_cmp_lg_u64 vcc, 0
  s_cselect_b32 s88, s97, 0
  s_cmp_lg_u32 s88, 0
  s_cbranch_scc1 Lrp_15
  s_branch Lok_14
Lre_16:
  s_mov_b32 s97, 20000
Lrp_18:
  buffer_load_dword v12, v21, s[84:87], s5 offen sc1
  s_waitcnt vmcnt(0)
  v_cmp_ne_u32 vcc, s95, v12
  s_sub_u32 s97, s97, 1
  s_cmp_lg_u64 vcc, 0
  s_cselect_b32 s88, s97, 0
  s_cmp_lg_u32 s88, 0
  s_nop 4
  s_cbranch_scc1 Lrp_18
  s_branch Lok_17
Lx_20:
  buffer_load_dwordx4 a[128:131], v2, s[84:87], s31 offen offset:0 sc1
Lx_21:
  buffer_load_dwordx4 v56, s[56:59], s37 offen offset:1024 lds
Lx_22:
  buffer_load_dwordx4 v12, s[56:59], s37 offen offset:2048 lds
Lx_23:
  buffer_load_dwordx4 a[192:195], v2, s[84:87], s32 offen offset:0 sc1
Lx_24:
  buffer_load_dwordx4 v13, s[56:59], s37 offen offset:3072 lds
  s_add_u32 m0, m0, 16384
  s_add_u32 s37, s37, 229376
Lx_25:
  buffer_load_dwordx4 v77, s[56:59], s37 offen offset:0 lds
Lx_26:
  buffer_load_dwordx4 a[132:135], v2, s[84:87], s31 offen offset:1024 sc1
Lx_27:
  buffer_load_dwordx4 v56, s[56:59], s37 offen offset:1024 lds
  s_nop 8
  s_branch Lp1_19
Lsk_30:
  buffer_load_dwordx4 v13, s[56:59], s37 offen offset:3072 lds
  s_add_u32 m0, m0, 16384
  s_add_u32 s37, s37, 229376
  buffer_load_dwordx4 v77, s[56:59], s37 offen offset:0 lds
  buffer_load_dwordx4 a[140:143], v2, s[84:87], s31 offen offset:3072 sc1
  s_add_u32 s31, s31, 4096
  buffer_load_dwordx4 v56, s[56:59], s37 offen offset:1024 lds
  buffer_load_dwordx4 v12, s[56:59], s37 offen offset:2048 lds
  buffer_load_dwordx4 a[204:207], v2, s[84:87], s32 offen offset:3072 sc1
  s_add_u32 s32, s32, 4096
  s_nop 7
  s_branch Lend_31
Lsk_32:
  buffer_load_dwordx4 v13, s[56:59], s37 offen offset:3072 lds
  s_add_u32 m0, m0, 16384
  s_add_u32 s37, s37, 229376
  buffer_load_dwordx4 v77, s[56:59], s37 offen offset:0 lds
  buffer_load_dwordx4 a[144:147], v2, s[84:87], s31 offen offset:0 sc1
  buffer_load_dwordx4 v56, s[56:59], s37 offen offset:1024 lds
  buffer_load_dwordx4 v12, s[56:59], s37 offen offset:2048 lds
  buffer_load_dwordx4 a[208:211], v2, s[84:87], s32 offen offset:0 sc1
  s_nop 9
  s_branch Lend_33
Lsk_34:
  buffer_load_dwordx4 v13, s[56:59], s37 offen offset:3072 lds
  s_add_u32 m0, m0, 16384
  s_add_u32 s37, s37, 229376
  buffer_load_dwordx4 v77, s[56:59], s37 offen offset:0 lds
  buffer_load_dwordx4 a[148:151], v2, s[84:87], s31 offen offset:1024 sc1
  buffer_load_dwordx4 v56, s[56:59], s37 offen offset:1024 lds
  buffer_load_dwordx4 v12, s[56:59], s37 offen offset:2048 lds
  buffer_load_dwordx4 a[212:215], v2, s[84:87], s32 offen offset:1024 sc1
  s_nop 9
  s_branch Lend_35
Lsk_36:
  buffer_load_dwordx4 v13, s[56:59], s37 offen offset:3072 lds
  s_add_u32 m0, m0, 16384
  s_add_u32 s37, s37, 229376
  buffer_load_dwordx4 a[152:155], v2, s[84:87], s31 offen offset:2048 sc1
  buffer_load_dwordx4 a[216:219], v2, s[84:87], s32 offen offset:2048 sc1
  buffer_load_dwordx4 a[156:159], v2, s[84:87], s31 offen offset:3072 sc1
  s_add_u32 s31, s31, 4096
  buffer_load_dwordx4 a[220:223], v2, s[84:87], s32 offen offset:3072 sc1
  s_add_u32 s32, s32, 4096
  buffer_load_dwordx4 a[160:163], v2, s[84:87], s31 offen offset:0 sc1
  s_nop 7
  s_branch Lend_37
Lsk_38:
  buffer_load_dwordx4 a[224:227], v2, s[84:87], s32 offen offset:0 sc1
  buffer_load_dwordx4 a[164:167], v2, s[84:87], s31 offen offset:1024 sc1
  buffer_load_dwordx4 a[228:231], v2, s[84:87], s32 offen offset:1024 sc1
  buffer_load_dwordx4 a[168:171], v2, s[84:87], s31 offen offset:2048 sc1
  buffer_load_dwordx4 a[232:235], v2, s[84:87], s32 offen offset:2048 sc1
  buffer_load_dwordx4 a[172:175], v2, s[84:87], s31 offen offset:3072 sc1
  s_add_u32 s31, s31, 4096
  s_nop 10
  s_branch Lend_39
Lsk_40:
  buffer_load_dwordx4 a[236:239], v2, s[84:87], s32 offen offset:3072 sc1
  s_add_u32 s32, s32, 4096
  buffer_load_dwordx4 a[176:179], v2, s[84:87], s31 offen offset:0 sc1
  buffer_load_dwordx4 a[240:243], v2, s[84:87], s32 offen offset:0 sc1
  buffer_load_dwordx4 a[180:183], v2, s[84:87], s31 offen offset:1024 sc1
  buffer_load_dwordx4 a[244:247], v2, s[84:87], s32 offen offset:1024 sc1
  buffer_load_dwordx4 a[184:187], v2, s[84:87], s31 offen offset:2048 sc1
  s_nop 10
  s_branch Lend_41
Lsk_42:
  buffer_load_dwordx4 a[248:251], v2, s[84:87], s32 offen offset:2048 sc1
  buffer_load_dwordx4 a[188:191], v2, s[84:87], s31 offen offset:3072 sc1
  s_add_u32 s31, s31, 4096
  buffer_load_dwordx4 a[252:255], v2, s[84:87], s32 offen offset:3072 sc1
  s_add_u32 s32, s32, 4096
  s_nop 11
  s_branch Lend_43
Lslow_45:
  buffer_store_dwordx4 v[110:113], v2, s[84:87], s76 offen sc1
  buffer_store_dwordx4 v[114:117], v2, s[84:87], s76 offen offset:1024 sc1
  s_nop 1
  s_branch Lse_46
Lre_47:
  s_mov_b32 s97, 20000
Lrp_49:
  buffer_load_dwordx4 v[58:61], v2, s[84:87], s77 offen sc1
  s_waitcnt vmcnt(0)
  v_xor_b32 v58, v3, v58
  v_bitop3_b32 v58, v58, v59, v3 bitop3:0xf6
  v_bitop3_b32 v58, v58, v60, v3 bitop3:0xf6
  v_bitop3_b32 v58, v58, v61, v3 bitop3:0xf6
  v_cmp_ne_u32 vcc, 0, v58
  s_sub_u32 s97, s97, 1
  s_cmp_lg_u64 vcc, 0
  s_cselect_b32 s88, s97, 0
  s_cmp_lg_u32 s88, 0
  s_cbranch_scc1 Lrp_49
  s_branch Lok_48
Lslow_50:
  buffer_store_dword v3, v4, s[84:87], s4 offen sc1
  s_nop 1
  s_branch Lse_51
Lre_52:
  s_mov_b32 s97, 20000
Lrp_54:
  buffer_load_dword v54, v76, s[84:87], s26 offen sc1
  s_waitcnt vmcnt(0)
  v_cmp_ne_u32 vcc, s95, v54
  s_sub_u32 s97, s97, 1
  s_cmp_lg_u64 vcc, 0
  s_cselect_b32 s88, s97, 0
  s_cmp_lg_u32 s88, 0
  s_nop 6
  s_cbranch_scc1 Lrp_54
  s_branch Lok_53
Lslow_55:
  buffer_store_dwordx4 v[230:233], v14, s[84:87], s5 offen sc1
  buffer_store_dwordx4 v[234:237], v14, s[84:87], s5 offen offset:512 sc1
  s_nop 1
  s_branch Lse_56
Lslow_57:
  buffer_store_dword v3, v4, s[84:87], s4 offen sc1
  s_nop 1
  s_branch Lse_58
Lre_61:
  s_mov_b32 s97, 20000
Lrp_63:
  buffer_load_dword v54, v55, s[84:87], s3 offen sc1
  s_waitcnt vmcnt(0)
  v_cmp_ne_u32 vcc, s95, v54
  s_sub_u32 s97, s97, 1
  s_cmp_lg_u64 vcc, 0
  s_cselect_b32 s88, s97, 0
  s_cmp_lg_u32 s88, 0
  s_nop 6
  s_cbranch_scc1 Lrp_63
  s_branch Lok_62
Lre_64:
  s_mov_b32 s97, 20000
Lrp_66:
  buffer_load_dwordx4 v[124:127], v2, s[84:87], s5 offen offset:0 sc1
  buffer_load_dwordx4 v[128:131], v2, s[84:87], s5 offen offset:1024 sc1
  buffer_load_dwordx4 v[132:135], v2, s[84:87], s5 offen offset:2048 sc1
  buffer_load_dwordx4 v[136:139], v2, s[84:87], s5 offen offset:3072 sc1
  buffer_load_dwordx4 v[140:143], v2, s[84:87], s11 offen offset:0 sc1
  buffer_load_dwordx4 v[144:147], v2, s[84:87], s11 offen offset:1024 sc1
  buffer_load_dwordx4 v[148:151], v2, s[84:87], s11 offen offset:2048 sc1
  buffer_load_dwordx4 v[152:155], v2, s[84:87], s11 offen offset:3072 sc1
  s_waitcnt vmcnt(0)
  v_xor_b32_e64 v127, v3, v127
  v_bitop3_b32 v127, v127, v131, v3 bitop3:0xf6
  v_bitop3_b32 v127, v127, v135, v3 bitop3:0xf6
  v_bitop3_b32 v127, v127, v139, v3 bitop3:0xf6
  v_bitop3_b32 v127, v127, v143, v3 bitop3:0xf6
  v_bitop3_b32 v127, v127, v147, v3 bitop3:0xf6
  v_bitop3_b32 v127, v127, v151, v3 bitop3:0xf6
  v_bitop3_b32 v127, v127, v155, v3 bitop3:0xf6
  v_cmp_ne_u32 vcc, 0, v127
  s_sub_u32 s97, s97, 1
  s_cmp_lg_u64 vcc, 0
  s_cselect_b32 s88, s97, 0
  s_cmp_lg_u32 s88, 0
  s_cbranch_scc1 Lrp_66
  s_branch Lok_65
Lslow_67:
  buffer_store_dwordx4 v[76:79], v14, s[84:87], s91 offen offset:0 sc1
  s_nop 1
  s_branch Lse_68
Lslow_69:
  buffer_store_dwordx4 v[80:83], v14, s[84:87], s91 offen offset:512 sc1
  s_nop 1
  s_branch Lse_70
Lslow_71:
  buffer_store_dword v3, v4, s[84:87], s4 offen sc1
  s_nop 1
  s_branch Lse_72
Lidle_59:
  s_and_b32 s98, s93, 1
  s_and_b32 s99, s94, 1
  s_mul_i32 s3, s98, 0xa8000
  s_mul_i32 s4, s99, 0x54000
  s_add_u32 s3, s3, s4
  s_mul_i32 s4, s92, 0x7000
  s_add_u32 s3, s3, s4
  s_lshl_b32 s4, s9, 12
  s_add_u32 s3, s3, s4
  s_add_u32 s3, s3, 0x1200000
  v_and_b32 v8, 0xf80, v6
  v_lshrrev_b32 v9, 5, v1
  v_mul_u32_u24 v9, 114688, v9
  v_add_u32 v8, v8, v9
  s_add_u32 s3, s3, 8192
  s_add_u32 s3, s3, 8192
  s_add_u32 s3, s3, s35
  s_add_u32 s3, s3, s36
  s_add_u32 s3, s3, 8192
  s_add_u32 s3, s3, 8192
  s_add_u32 s3, s3, 8192
  buffer_load_dwordx4 a[52:55], v2, s[84:87], s34 offen offset:2048 sc1
  buffer_load_dwordx4 a[56:59], v2, s[84:87], s33 offen offset:3072 sc1
  s_add_u32 s33, s33, 8192
  buffer_load_dwordx4 a[60:63], v2, s[84:87], s34 offen offset:3072 sc1
  s_add_u32 s34, s34, 8192
  buffer_load_dwordx4 a[64:67], v2, s[84:87], s33 offen offset:0 sc1
  buffer_load_dwordx4 a[68:71], v2, s[84:87], s34 offen offset:0 sc1
  buffer_load_dwordx4 a[72:75], v2, s[84:87], s33 offen offset:1024 sc1
  buffer_load_dwordx4 a[76:79], v2, s[84:87], s34 offen offset:1024 sc1
  buffer_load_dwordx4 a[80:83], v2, s[84:87], s33 offen offset:2048 sc1
  buffer_load_dwordx4 a[84:87], v2, s[84:87], s34 offen offset:2048 sc1
  buffer_load_dwordx4 a[88:91], v2, s[84:87], s33 offen offset:3072 sc1
  s_add_u32 s33, s33, s35
  buffer_load_dwordx4 a[92:95], v2, s[84:87], s34 offen offset:3072 sc1
  s_add_u32 s34, s34, s35
  buffer_load_dwordx4 a[96:99], v2, s[84:87], s33 offen offset:0 sc1
  buffer_load_dwordx4 a[100:103], v2, s[84:87], s34 offen offset:0 sc1
  buffer_load_dwordx4 a[104:107], v2, s[84:87], s33 offen offset:1024 sc1
  buffer_load_dwordx4 a[108:111], v2, s[84:87], s34 offen offset:1024 sc1
  buffer_load_dwordx4 a[112:115], v2, s[84:87], s33 offen offset:2048 sc1
  buffer_load_dwordx4 a[116:119], v2, s[84:87], s34 offen offset:2048 sc1
  buffer_load_dwordx4 a[120:123], v2, s[84:87], s33 offen offset:3072 sc1
  s_add_u32 s33, s33, s36
  buffer_load_dwordx4 a[124:127], v2, s[84:87], s34 offen offset:3072 sc1
  s_add_u32 s34, s34, s36
  buffer_load_dwordx4 a[128:131], v2, s[84:87], s33 offen offset:0 sc1
  buffer_load_dwordx4 a[132:135], v2, s[84:87], s34 offen offset:0 sc1
  buffer_load_dwordx4 a[136:139], v2, s[84:87], s33 offen offset:1024 sc1
  buffer_load_dwordx4 a[140:143], v2, s[84:87], s34 offen offset:1024 sc1
  buffer_load_dwordx4 a[144:147], v2, s[84:87], s33 offen offset:2048 sc1
  buffer_load_dwordx4 a[148:151], v2, s[84:87], s34 offen offset:2048 sc1
  buffer_load_dwordx4 a[152:155], v2, s[84:87], s33 offen offset:3072 sc1
  s_add_u32 s33, s33, 8192
  buffer_load_dwordx4 a[156:159], v2, s[84:87], s34 offen offset:3072 sc1
  s_add_u32 s34, s34, 8192
  buffer_load_dwordx4 a[160:163], v2, s[84:87], s33 offen offset:0 sc1
  buffer_load_dwordx4 a[164:167], v2, s[84:87], s34 offen offset:0 sc1
  buffer_load_dwordx4 a[168:171], v2, s[84:87], s33 offen offset:1024 sc1
  buffer_load_dwordx4 a[172:175], v2, s[84:87], s34 offen offset:1024 sc1
  buffer_load_dwordx4 a[176:179], v2, s[84:87], s33 offen offset:2048 sc1
  buffer_load_dwordx4 a[180:183], v2, s[84:87], s34 offen offset:2048 sc1
  buffer_load_dwordx4 a[184:187], v2, s[84:87], s33 offen offset:3072 sc1
  s_add_u32 s33, s33, 8192
  buffer_load_dwordx4 a[188:191], v2, s[84:87], s34 offen offset:3072 sc1
  s_add_u32 s34, s34, 8192
  buffer_load_dwordx4 a[192:195], v2, s[84:87], s33 offen offset:0 sc1
  buffer_load_dwordx4 a[196:199], v2, s[84:87], s34 offen offset:0 sc1
  buffer_load_dwordx4 a[200:203], v2, s[84:87], s33 offen offset:1024 sc1
  buffer_load_dwordx4 a[204:207], v2, s[84:87], s34 offen offset:1024 sc1
  buffer_load_dwordx4 a[208:211], v2, s[84:87], s33 offen offset:2048 sc1
  buffer_load_dwordx4 a[212:215], v2, s[84:87], s34 offen offset:2048 sc1
  buffer_load_dwordx4 a[216:219], v2, s[84:87], s33 offen offset:3072 sc1
  s_add_u32 s33, s33, 8192
  buffer_load_dwordx4 a[220:223], v2, s[84:87], s34 offen offset:3072 sc1
  s_add_u32 s34, s34, 8192
  s_mov_b32 s97, 20000
Lrp_73:
  s_sleep 8
  buffer_load_dword v54, v50, s[84:87], s26 offen sc1
  s_waitcnt vmcnt(0)
  v_cmp_ne_u32 vcc, s95, v54
  s_sub_u32 s97, s97, 1
  s_cmp_lg_u64 vcc, 0
  s_cselect_b32 s88, s97, 0
  s_cmp_lg_u32 s88, 0
  s_cbranch_scc1 Lrp_73
  s_branch Lback_60
Lre_76:
  s_mov_b32 s97, 20000
Lrp_78:
  buffer_load_dword v54, v50, s[84:87], s26 offen sc1
  s_waitcnt vmcnt(0)
  v_cmp_ne_u32 vcc, s95, v54
  s_sub_u32 s97, s97, 1
  s_cmp_lg_u64 vcc, 0
  s_cselect_b32 s88, s97, 0
  s_cmp_lg_u32 s88, 0
  s_cbranch_scc1 Lrp_78
  s_branch Lok_77
Lslow_79:
  buffer_store_dword v3, v4, s[84:87], s4 offen sc1
  s_nop 1
  s_branch Lse_80
Lre_81:
  s_mov_b32 s97, 20000
Lrp_83:
  buffer_load_dword v54, v50, s[84:87], s26 offen offset:256 sc1
  s_waitcnt vmcnt(0)
  v_cmp_ne_u32 vcc, s95, v54
  s_sub_u32 s97, s97, 1
  s_cmp_lg_u64 vcc, 0
  s_cselect_b32 s88, s97, 0
  s_cmp_lg_u32 s88, 0
  s_nop 6
  s_cbranch_scc1 Lrp_83
  s_branch Lok_82
Lcode_end:
  s_endpgm
.section .rodata,"a"
.p2align 6
.amdhsa_kernel adaLN_cond__sliding_block__mixer_channel_mlp__prompt_kernel
  .amdhsa_next_free_vgpr 512
  .amdhsa_next_free_sgpr 102
  .amdhsa_accum_offset 256
  .amdhsa_group_segment_fixed_size 0
  .amdhsa_kernarg_size 104
  .amdhsa_user_sgpr_count 2
  .amdhsa_user_sgpr_kernarg_segment_ptr 1
  .amdhsa_system_sgpr_workgroup_id_x 1
.end_amdhsa_kernel
```
